```python
import torch

def _softmax(x, axis=-1):
    return torch.softmax(x, dim=axis)
def _gelu(x):
    return torch.nn.functional.gelu(x, approximate="tanh")
def _silu(x):
    return torch.nn.functional.silu(x)
def _sigmoid(x):
    return torch.sigmoid(x)
def _layernorm(x, axis=-1, eps=1e-5):
    m = x.mean(dim=axis, keepdim=True)
    v = x.var(dim=axis, keepdim=True, unbiased=False)
    return (x - m) / torch.sqrt(v + eps)
def _scatter_add(tgt, idx, src, axis=0):
    return tgt.clone().index_add_(axis, idx, src)
def _segment_sum(src, seg, n):
    out = torch.zeros((n,) + src.shape[1:], dtype=src.dtype)
    return out.index_add_(0, seg, src)
def _pad(x, pw):
    flat = tuple(v for pair in reversed(pw) for v in pair)
    return torch.nn.functional.pad(x, flat)

kernel_name = 'parallel_sum__gqa_block_cached__swiglu_ffn__decode'

def setup_inputs():

    _w = (lambda a: (lambda t: t.to(torch.bfloat16) if t.is_floating_point() else t)(torch.as_tensor(a)))
    def _A_setup():
        B, Sq, D = 2, 1, 1024
        Hq, Hkv, Sk, Dh = 32, 4, 32768, 128
        assert Hq % Hkv == 0, (Hq, Hkv)
        return {
            "x": _w((lambda *s: torch.randn(*s, dtype=torch.bfloat16) * 0.05)(B, Sq, D)),
            "k_cache": _w((lambda *s: torch.randn(*s, dtype=torch.bfloat16) * 3.2)(B, Hkv, Sk, Dh)),
            "v_cache": _w((lambda *s: torch.randn(*s, dtype=torch.bfloat16) * 1.6)(B, Hkv, Sk, Dh)),
            "wq": _w((lambda *s: torch.randn(*s, dtype=torch.bfloat16) * 3.2)(D, Hq * Dh) * (D ** -0.5)),
            "wo": _w((lambda *s: torch.randn(*s, dtype=torch.bfloat16) * 1.6)(Hq * Dh, D) * ((Hq * Dh) ** -0.5)),
        }
    _A_in = _A_setup()

    def _B_setup():
        B, S, D, F = 2, 1, 1024, 3584
        return {
            "x": _w((lambda *s: torch.randn(*s, dtype=torch.bfloat16) * 0.05)(B, S, D)),
            "w_gate": _w((lambda *s: torch.randn(*s, dtype=torch.bfloat16) * 0.05)(D, F)),
            "w_up": _w((lambda *s: torch.randn(*s, dtype=torch.bfloat16) * 0.05)(D, F)),
            "w_down": _w((lambda *s: torch.randn(*s, dtype=torch.bfloat16) * 0.05)(F, D)),
        }
    _B_in = _B_setup()

    return {
        "A_x": _A_in["x"],
        "A_k_cache": _A_in["k_cache"],
        "A_v_cache": _A_in["v_cache"],
        "A_wq": _A_in["wq"],
        "A_wo": _A_in["wo"],
        "B_x": _B_in["x"],
        "B_w_gate": _B_in["w_gate"],
        "B_w_up": _B_in["w_up"],
        "B_w_down": _B_in["w_down"],
    }

def reference(A_x, A_k_cache, A_v_cache, A_wq, A_wo, B_x, B_w_gate, B_w_up, B_w_down):
    def _A_ref(x, k_cache, v_cache, wq, wo):
        B, Sq, D = x.shape
        Hq, Dh = 32, 128
        Hkv = k_cache.shape[1]
        rep = Hq // Hkv
        q = (lambda x, *d: x.permute(*d))((x @ wq).reshape(B, Sq, Hq, Dh), 0, 2, 1, 3)
        k = (lambda x, n, axis: torch.repeat_interleave(x, n, dim=axis))(k_cache, rep, axis=1)
        v = (lambda x, n, axis: torch.repeat_interleave(x, n, dim=axis))(v_cache, rep, axis=1)
        scores = torch.einsum("bhqd,bhkd->bhqk", q, k) * (Dh ** -0.5)
        p = _softmax(scores, axis=-1)
        o = torch.einsum("bhqk,bhkd->bhqd", p, v)
        return (lambda x, *d: x.permute(*d))(o, 0, 2, 1, 3).reshape(B, Sq, Hq * Dh) @ wo

    def _B_ref(x, w_gate, w_up, w_down):
        g = _silu(x @ w_gate)
        u = x @ w_up
        return (g * u) @ w_down

    x = A_x
    xn = _layernorm(x, axis=-1)
    return x + _A_ref(xn, A_k_cache, A_v_cache, A_wq, A_wo) + _B_ref(xn, B_w_gate, B_w_up, B_w_down)
```

```asm
; @launch grid=(256,1,1) block=(256,1,1) lds=19456
.amdgcn_target "amdgcn-amd-amdhsa--gfx950"
.text
.globl parallel_sum__gqa_block_cached__swiglu_ffn__decode_kernel
.p2align 8
.type parallel_sum__gqa_block_cached__swiglu_ffn__decode_kernel,@function
parallel_sum__gqa_block_cached__swiglu_ffn__decode_kernel:

    s_cmp_ge_u32 s2, 256
    s_cbranch_scc1 L_end

    s_load_dwordx16 s[4:19], s[0:1], 0
    s_load_dwordx8 s[20:27], s[0:1], 64
    v_and_b32 v1, 63, v0
    v_lshrrev_b32 v10, 6, v0
    s_nop 0
    v_readfirstlane_b32 s3, v10
    s_mov_b32 s72, 0xffff0000
    s_mov_b32 s100, 0x05040100
    s_mov_b32 s101, 0x07060302

    s_mov_b32 s97, s2
    s_and_b32 s96, s97, 3
    s_lshr_b32 s97, s97, 2
    s_lshl_b32 s98, s96, 8
    v_lshrrev_b32 v11, 3, v1
    v_lshlrev_b32 v12, 6, v10
    v_add_u32 v11, v11, v12
    v_add_u32 v11, s98, v11
    v_and_b32 v12, 7, v1
    v_lshlrev_b32 v12, 4, v12
    v_lshlrev_b32 v2, 13, v11
    v_add_u32 v2, v2, v12
    s_movk_i32 s73, 7168
    v_mul_lo_u32 v3, v11, s73
    v_add_u32 v3, v3, v12
    v_lshlrev_b32 v4, 5, v1
    v_lshlrev_b32 v5, 6, v10
    v_add_u32 v5, v5, v1
    v_add_u32 v5, s98, v5
    v_lshlrev_b32 v5, 1, v5
    v_lshlrev_b32 v57, 3, v0
    v_and_b32 v11, 3, v1
    v_lshlrev_b32 v11, 2, v11
    v_bfe_u32 v12, v1, 2, 1
    v_add_u32 v11, v11, v12
    v_lshlrev_b32 v11, 8, v11
    v_lshrrev_b32 v12, 4, v1
    v_lshlrev_b32 v12, 4, v12
    v_add_u32 v11, v11, v12
    v_bfe_u32 v12, v1, 3, 1
    v_lshlrev_b32 v12, 6, v12
    v_add_u32 v11, v11, v12
    v_lshlrev_b32 v12, 16, v10
    v_add_u32 v6, v11, v12
    v_add_u32 v7, 4096, v6
    v_lshlrev_b32 v11, 4, v1
    v_add_u32 v8, v11, v12
    v_add_u32 v9, 4096, v8
    s_waitcnt lgkmcnt(0)
    s_lshl_b32 s0, s97, 2
    s_add_u32 s0, s0, s96

s_mov_b32 s28, s4
s_and_b32 s29, s5, 0xffff
s_mov_b32 s30, 4096
s_mov_b32 s31, 0x20000
buffer_load_dwordx4 v[16:19], v4, s[28:31], 0 offen offset:0
buffer_load_dwordx4 v[20:23], v4, s[28:31], 0 offen offset:16
buffer_load_dwordx4 v[24:27], v4, s[28:31], 0 offen offset:2048
buffer_load_dwordx4 v[28:31], v4, s[28:31], 0 offen offset:2064
buffer_load_ushort v32, v5, s[28:31], 0 offen offset:0
buffer_load_ushort v33, v5, s[28:31], 0 offen offset:2048
s_lshl_b32 s73, s97, 7
s_add_u32 s32, s10, s73
s_addc_u32 s33, s11, 0
s_and_b32 s33, s33, 0xffff
s_mov_b32 s34, 0
s_mov_b32 s35, 0x20000
s_sub_u32 s34, 0x800000, s73
s_mov_b32 s74, 0
buffer_load_dwordx4 v[128:131], v2, s[32:35], s74 offen nt
s_add_u32 s74, s74, 65536
buffer_load_dwordx4 v[132:135], v2, s[32:35], s74 offen nt
s_add_u32 s74, s74, 65536
buffer_load_dwordx4 v[136:139], v2, s[32:35], s74 offen nt
s_add_u32 s74, s74, 65536
buffer_load_dwordx4 v[140:143], v2, s[32:35], s74 offen nt
s_add_u32 s74, s74, 65536
buffer_load_dwordx4 v[144:147], v2, s[32:35], s74 offen nt
s_add_u32 s74, s74, 65536
buffer_load_dwordx4 v[148:151], v2, s[32:35], s74 offen nt
s_add_u32 s74, s74, 65536
buffer_load_dwordx4 v[152:155], v2, s[32:35], s74 offen nt
s_add_u32 s74, s74, 65536
buffer_load_dwordx4 v[156:159], v2, s[32:35], s74 offen nt
s_lshl_b32 s73, s97, 7
s_xor_b32 s73, s73, 256
s_add_u32 s36, s16, s73
s_addc_u32 s37, s17, 0
s_and_b32 s37, s37, 0xffff
s_mov_b32 s38, 0
s_mov_b32 s39, 0x20000
s_sub_u32 s99, 7340032, s73
s_xor_b32 s73, s73, 768
s_add_u32 s40, s18, s73
s_addc_u32 s41, s19, 0
s_and_b32 s41, s41, 0xffff
s_mov_b32 s42, 0
s_mov_b32 s43, 0x20000

    s_sub_u32 s74, 7340032, s73
    s_cmp_lt_u32 s0, 224
    s_cselect_b32 s38, s99, 0
    s_cselect_b32 s42, s74, 0
    s_mov_b32 s74, 0

buffer_load_dwordx4 v[160:163], v3, s[36:39], s74 offen nt
s_add_u32 s74, s74, 57344
buffer_load_dwordx4 v[164:167], v3, s[36:39], s74 offen nt
s_add_u32 s74, s74, 57344
buffer_load_dwordx4 v[168:171], v3, s[36:39], s74 offen nt
s_add_u32 s74, s74, 57344
buffer_load_dwordx4 v[172:175], v3, s[36:39], s74 offen nt
s_add_u32 s74, s74, 57344
buffer_load_dwordx4 v[176:179], v3, s[36:39], s74 offen nt
s_add_u32 s74, s74, 57344
buffer_load_dwordx4 v[180:183], v3, s[36:39], s74 offen nt
s_add_u32 s74, s74, 57344
buffer_load_dwordx4 v[184:187], v3, s[36:39], s74 offen nt
s_add_u32 s74, s74, 57344
buffer_load_dwordx4 v[188:191], v3, s[36:39], s74 offen nt
s_mov_b32 s74, 0
buffer_load_dwordx4 v[192:195], v3, s[40:43], s74 offen nt
s_add_u32 s74, s74, 57344
buffer_load_dwordx4 v[196:199], v3, s[40:43], s74 offen nt
s_add_u32 s74, s74, 57344
buffer_load_dwordx4 v[200:203], v3, s[40:43], s74 offen nt
s_add_u32 s74, s74, 57344
buffer_load_dwordx4 v[204:207], v3, s[40:43], s74 offen nt
s_add_u32 s74, s74, 57344
buffer_load_dwordx4 v[208:211], v3, s[40:43], s74 offen nt
s_add_u32 s74, s74, 57344
buffer_load_dwordx4 v[212:215], v3, s[40:43], s74 offen nt
s_add_u32 s74, s74, 57344
buffer_load_dwordx4 v[216:219], v3, s[40:43], s74 offen nt
s_add_u32 s74, s74, 57344
buffer_load_dwordx4 v[220:223], v3, s[40:43], s74 offen nt
s_mov_b32 s60, s26
s_and_b32 s61, s27, 0xffff
s_mov_b32 s62, 4194304
s_mov_b32 s63, 0x20000

        v_mov_b32 v112, -1
        v_mov_b32 v113, -1
        v_mov_b32 v114, -1
        v_mov_b32 v115, -1
        v_lshlrev_b32 v11, 4, v0
        s_lshl_b32 s73, s2, 12
        s_add_u32 s73, s73, 1048576

buffer_store_dwordx4 v[112:115], v11, s[60:63], s73 offen sc1

        s_lshl_b32 s73, s2, 13
        s_add_u32 s73, s73, 2097152

buffer_store_dwordx4 v[112:115], v11, s[60:63], s73 offen sc1
s_add_u32 s73, s73, 4096
buffer_store_dwordx4 v[112:115], v11, s[60:63], s73 offen sc1

        v_lshlrev_b32 v12, 4, v10
        s_lshl_b32 s73, s2, 6
        s_add_u32 s73, s73, 393216
        s_mov_b64 exec, 1

buffer_store_dwordx4 v[112:115], v12, s[60:63], s73 offen sc1
s_mov_b64 exec, -1
s_lshl_b32 s73, s0, 15
s_add_u32 s52, s20, s73
s_addc_u32 s53, s21, 0
s_and_b32 s53, s53, 0xffff
s_mov_b32 s54, 0
s_mov_b32 s55, 0x20000

    s_cmp_lt_u32 s0, 224
    s_cselect_b32 s54, 0x8000, 0

s_mov_b32 s99, s2
s_lshl_b32 s73, s99, 18
s_add_u32 s44, s6, s73
s_addc_u32 s45, s7, 0
s_and_b32 s45, s45, 0xffff
s_mov_b32 s46, 262144
s_mov_b32 s47, 0x20000
s_add_u32 s48, s8, s73
s_addc_u32 s49, s9, 0
s_and_b32 s49, s49, 0xffff
s_mov_b32 s50, 262144
s_mov_b32 s51, 0x20000

    s_lshr_b32 s73, s2, 3
    s_lshl_b32 s73, s73, 7
    s_bfe_u32 s74, s2, 0x20001
    s_lshl_b32 s74, s74, 5
    s_add_u32 s73, s73, s74
    s_and_b32 s74, s2, 1
    s_lshl_b32 s74, s74, 2
    s_add_u32 s73, s73, s74
    s_lshl_b32 s73, s73, 11

s_add_u32 s56, s12, s73
s_addc_u32 s57, s13, 0
s_and_b32 s57, s57, 0xffff
s_mov_b32 s58, 57344
s_mov_b32 s59, 0x20000
s_mov_b32 s64, s22
s_and_b32 s65, s23, 0xffff
s_mov_b32 s66, 4096
s_mov_b32 s67, 0x20000
s_mov_b32 s68, s24
s_and_b32 s69, s25, 0xffff
s_mov_b32 s70, 256
s_mov_b32 s71, 0x20000

    s_lshr_b32 s4, s99, 7
    s_bfe_u32 s5, s99, 0x20005
    s_and_b32 s6, s99, 31
    s_mov_b32 s7, s97
    s_mov_b32 s8, s96
    s_and_b32 s73, s2, 127
    s_lshl_b32 s73, s73, 4
    s_lshr_b32 s74, s2, 7
    s_lshl_b32 s74, s74, 11
    s_add_u32 s9, s73, s74

s_waitcnt vmcnt(28)
v_lshlrev_b32 v64, 16, v16
v_and_b32 v65, s72, v16
v_lshlrev_b32 v66, 16, v17
v_and_b32 v67, s72, v17
v_lshlrev_b32 v68, 16, v18
v_and_b32 v69, s72, v18
v_lshlrev_b32 v70, 16, v19
v_and_b32 v71, s72, v19
v_lshlrev_b32 v72, 16, v20
v_and_b32 v73, s72, v20
v_lshlrev_b32 v74, 16, v21
v_and_b32 v75, s72, v21
v_lshlrev_b32 v76, 16, v22
v_and_b32 v77, s72, v22
v_lshlrev_b32 v78, 16, v23
v_and_b32 v79, s72, v23
v_lshlrev_b32 v80, 16, v24
v_and_b32 v81, s72, v24
v_lshlrev_b32 v82, 16, v25
v_and_b32 v83, s72, v25
v_lshlrev_b32 v84, 16, v26
v_and_b32 v85, s72, v26
v_lshlrev_b32 v86, 16, v27
v_and_b32 v87, s72, v27
v_lshlrev_b32 v88, 16, v28
v_and_b32 v89, s72, v28
v_lshlrev_b32 v90, 16, v29
v_and_b32 v91, s72, v29
v_lshlrev_b32 v92, 16, v30
v_and_b32 v93, s72, v30
v_lshlrev_b32 v94, 16, v31
v_and_b32 v95, s72, v31
v_add_f32 v96, v64, v65
v_add_f32 v97, v80, v81
v_add_f32 v96, v96, v66
v_add_f32 v97, v97, v82
v_add_f32 v96, v96, v67
v_add_f32 v97, v97, v83
v_add_f32 v96, v96, v68
v_add_f32 v97, v97, v84
v_add_f32 v96, v96, v69
v_add_f32 v97, v97, v85
v_add_f32 v96, v96, v70
v_add_f32 v97, v97, v86
v_add_f32 v96, v96, v71
v_add_f32 v97, v97, v87
v_add_f32 v96, v96, v72
v_add_f32 v97, v97, v88
v_add_f32 v96, v96, v73
v_add_f32 v97, v97, v89
v_add_f32 v96, v96, v74
v_add_f32 v97, v97, v90
v_add_f32 v96, v96, v75
v_add_f32 v97, v97, v91
v_add_f32 v96, v96, v76
v_add_f32 v97, v97, v92
v_add_f32 v96, v96, v77
v_add_f32 v97, v97, v93
v_add_f32 v96, v96, v78
v_add_f32 v97, v97, v94
v_add_f32 v96, v96, v79
v_add_f32 v97, v97, v95
    s_nop 0
v_add_f32_dpp v96, v96, v96 row_ror:8 row_mask:0xf bank_mask:0xf
v_add_f32_dpp v97, v97, v97 row_ror:8 row_mask:0xf bank_mask:0xf
    s_nop 0
v_add_f32_dpp v96, v96, v96 row_ror:4 row_mask:0xf bank_mask:0xf
v_add_f32_dpp v97, v97, v97 row_ror:4 row_mask:0xf bank_mask:0xf
    s_nop 0
v_add_f32_dpp v96, v96, v96 row_ror:2 row_mask:0xf bank_mask:0xf
v_add_f32_dpp v97, v97, v97 row_ror:2 row_mask:0xf bank_mask:0xf
    s_nop 0
v_add_f32_dpp v96, v96, v96 row_ror:1 row_mask:0xf bank_mask:0xf
v_add_f32_dpp v97, v97, v97 row_ror:1 row_mask:0xf bank_mask:0xf
v_mov_b32 v104, v96
v_mov_b32 v105, v97
    s_nop 0
v_permlane16_swap_b32 v96, v104
v_permlane16_swap_b32 v97, v105
v_add_f32 v96, v96, v104
v_add_f32 v97, v97, v105
v_mov_b32 v104, v96
v_mov_b32 v105, v97
    s_nop 0
v_permlane32_swap_b32 v96, v104
v_permlane32_swap_b32 v97, v105
v_add_f32 v96, v96, v104
v_add_f32 v97, v97, v105
v_mul_f32 v96, 0x3a800000, v96
v_mul_f32 v97, 0x3a800000, v97
v_sub_f32 v64, v64, v96
v_sub_f32 v80, v80, v97
v_sub_f32 v65, v65, v96
v_sub_f32 v81, v81, v97
v_sub_f32 v66, v66, v96
v_sub_f32 v82, v82, v97
v_sub_f32 v67, v67, v96
v_sub_f32 v83, v83, v97
v_sub_f32 v68, v68, v96
v_sub_f32 v84, v84, v97
v_sub_f32 v69, v69, v96
v_sub_f32 v85, v85, v97
v_sub_f32 v70, v70, v96
v_sub_f32 v86, v86, v97
v_sub_f32 v71, v71, v96
v_sub_f32 v87, v87, v97
v_sub_f32 v72, v72, v96
v_sub_f32 v88, v88, v97
v_sub_f32 v73, v73, v96
v_sub_f32 v89, v89, v97
v_sub_f32 v74, v74, v96
v_sub_f32 v90, v90, v97
v_sub_f32 v75, v75, v96
v_sub_f32 v91, v91, v97
v_sub_f32 v76, v76, v96
v_sub_f32 v92, v92, v97
v_sub_f32 v77, v77, v96
v_sub_f32 v93, v93, v97
v_sub_f32 v78, v78, v96
v_sub_f32 v94, v94, v97
v_sub_f32 v79, v79, v96
v_sub_f32 v95, v95, v97
v_mul_f32 v98, v64, v64
v_mul_f32 v99, v80, v80
v_fmac_f32 v98, v65, v65
v_fmac_f32 v99, v81, v81
v_fmac_f32 v98, v66, v66
v_fmac_f32 v99, v82, v82
v_fmac_f32 v98, v67, v67
v_fmac_f32 v99, v83, v83
v_fmac_f32 v98, v68, v68
v_fmac_f32 v99, v84, v84
v_fmac_f32 v98, v69, v69
v_fmac_f32 v99, v85, v85
v_fmac_f32 v98, v70, v70
v_fmac_f32 v99, v86, v86
v_fmac_f32 v98, v71, v71
v_fmac_f32 v99, v87, v87
v_fmac_f32 v98, v72, v72
v_fmac_f32 v99, v88, v88
v_fmac_f32 v98, v73, v73
v_fmac_f32 v99, v89, v89
v_fmac_f32 v98, v74, v74
v_fmac_f32 v99, v90, v90
v_fmac_f32 v98, v75, v75
v_fmac_f32 v99, v91, v91
v_fmac_f32 v98, v76, v76
v_fmac_f32 v99, v92, v92
v_fmac_f32 v98, v77, v77
v_fmac_f32 v99, v93, v93
v_fmac_f32 v98, v78, v78
v_fmac_f32 v99, v94, v94
v_fmac_f32 v98, v79, v79
v_fmac_f32 v99, v95, v95
    s_nop 0
v_add_f32_dpp v98, v98, v98 row_ror:8 row_mask:0xf bank_mask:0xf
v_add_f32_dpp v99, v99, v99 row_ror:8 row_mask:0xf bank_mask:0xf
    s_nop 0
v_add_f32_dpp v98, v98, v98 row_ror:4 row_mask:0xf bank_mask:0xf
v_add_f32_dpp v99, v99, v99 row_ror:4 row_mask:0xf bank_mask:0xf
    s_nop 0
v_add_f32_dpp v98, v98, v98 row_ror:2 row_mask:0xf bank_mask:0xf
v_add_f32_dpp v99, v99, v99 row_ror:2 row_mask:0xf bank_mask:0xf
    s_nop 0
v_add_f32_dpp v98, v98, v98 row_ror:1 row_mask:0xf bank_mask:0xf
v_add_f32_dpp v99, v99, v99 row_ror:1 row_mask:0xf bank_mask:0xf
v_mov_b32 v104, v98
v_mov_b32 v105, v99
    s_nop 0
v_permlane16_swap_b32 v98, v104
v_permlane16_swap_b32 v99, v105
v_add_f32 v98, v98, v104
v_add_f32 v99, v99, v105
v_mov_b32 v104, v98
v_mov_b32 v105, v99
    s_nop 0
v_permlane32_swap_b32 v98, v104
v_permlane32_swap_b32 v99, v105
v_add_f32 v98, v98, v104
v_add_f32 v99, v99, v105
v_mul_f32 v98, 0x3a800000, v98
v_cvt_pk_bf16_f32 v98, v98, v98
v_and_b32 v98, s72, v98
v_add_f32 v98, 0x3727c5ac, v98
v_cvt_pk_bf16_f32 v98, v98, v98
v_and_b32 v98, s72, v98
v_sqrt_f32 v98, v98
    s_nop 0
v_cvt_pk_bf16_f32 v98, v98, v98
v_and_b32 v98, s72, v98
v_cvt_pk_bf16_f32 v96, v96, v96
v_and_b32 v96, s72, v96
v_rcp_f32 v100, v98
v_mul_f32 v99, 0x3a800000, v99
v_cvt_pk_bf16_f32 v99, v99, v99
v_and_b32 v99, s72, v99
v_add_f32 v99, 0x3727c5ac, v99
v_cvt_pk_bf16_f32 v99, v99, v99
v_and_b32 v99, s72, v99
v_sqrt_f32 v99, v99
    s_nop 0
v_cvt_pk_bf16_f32 v99, v99, v99
v_and_b32 v99, s72, v99
v_cvt_pk_bf16_f32 v97, v97, v97
v_and_b32 v97, s72, v97
v_rcp_f32 v101, v99
v_lshlrev_b32 v64, 16, v32
v_lshlrev_b32 v65, 16, v33
v_sub_f32 v64, v64, v96
v_sub_f32 v65, v65, v97
v_cvt_pk_bf16_f32 v64, v64, v64
v_and_b32 v64, s72, v64
v_cvt_pk_bf16_f32 v65, v65, v65
v_and_b32 v65, s72, v65
v_mul_f32 v102, v64, v100
v_fma_f32 v103, -v102, v98, v64
v_fma_f32 v64, v103, v100, v102
v_mul_f32 v102, v65, v101
v_fma_f32 v103, -v102, v99, v65
v_fma_f32 v65, v103, v101, v102
v_cvt_pk_bf16_f32 v64, v64, v64
v_and_b32 v64, s72, v64
v_cvt_pk_bf16_f32 v65, v65, v65
v_and_b32 v65, s72, v65

    v_lshlrev_b32 v11, 9, v10
    v_lshlrev_b32 v12, 3, v1
    v_add_u32 v12, v12, v11
    ds_write_b64 v12, v[64:65] offset:8704
    v_lshrrev_b32 v12, 3, v1
    v_lshlrev_b32 v12, 3, v12
    v_add_u32 v12, v12, v11
    s_waitcnt lgkmcnt(0)

ds_read_b64 v[40:41], v12 offset:8704
ds_read_b64 v[42:43], v12 offset:8768
ds_read_b64 v[44:45], v12 offset:8832
ds_read_b64 v[46:47], v12 offset:8896
ds_read_b64 v[48:49], v12 offset:8960
ds_read_b64 v[50:51], v12 offset:9024
ds_read_b64 v[52:53], v12 offset:9088
ds_read_b64 v[54:55], v12 offset:9152

    v_and_b32 v14, 7, v1
    v_lshlrev_b32 v14, 5, v14
    v_lshrrev_b32 v12, 4, v1
    v_lshlrev_b32 v12, 3, v12
    v_add_u32 v14, v14, v12
    v_add_u32 v14, v14, v11
    s_waitcnt lgkmcnt(0)

s_mov_b32 s74, 0
buffer_load_dwordx4 a[0:3], v6, s[44:47], s74 offen offset:0 nt
buffer_load_dwordx4 a[4:7], v6, s[44:47], s74 offen offset:128 nt
buffer_load_dwordx4 a[8:11], v6, s[44:47], s74 offen offset:512 nt
buffer_load_dwordx4 a[12:15], v6, s[44:47], s74 offen offset:640 nt
buffer_load_dwordx4 a[16:19], v7, s[44:47], s74 offen offset:0 nt
buffer_load_dwordx4 a[20:23], v7, s[44:47], s74 offen offset:128 nt
buffer_load_dwordx4 a[24:27], v7, s[44:47], s74 offen offset:512 nt
buffer_load_dwordx4 a[28:31], v7, s[44:47], s74 offen offset:640 nt
s_waitcnt vmcnt(28)
v_lshlrev_b32 v112, 16, v128
v_and_b32 v113, s72, v128
v_pk_mul_f32 v[96:97], v[112:113], v[40:41] op_sel:[0,0] op_sel_hi:[0,1]
v_pk_mul_f32 v[98:99], v[112:113], v[40:41] op_sel:[1,0] op_sel_hi:[1,1]
v_lshlrev_b32 v114, 16, v129
v_and_b32 v115, s72, v129
v_pk_mul_f32 v[100:101], v[114:115], v[40:41] op_sel:[0,0] op_sel_hi:[0,1]
v_pk_mul_f32 v[102:103], v[114:115], v[40:41] op_sel:[1,0] op_sel_hi:[1,1]
v_lshlrev_b32 v112, 16, v130
v_and_b32 v113, s72, v130
v_pk_mul_f32 v[104:105], v[112:113], v[40:41] op_sel:[0,0] op_sel_hi:[0,1]
v_pk_mul_f32 v[106:107], v[112:113], v[40:41] op_sel:[1,0] op_sel_hi:[1,1]
v_lshlrev_b32 v114, 16, v131
v_and_b32 v115, s72, v131
v_pk_mul_f32 v[108:109], v[114:115], v[40:41] op_sel:[0,0] op_sel_hi:[0,1]
v_pk_mul_f32 v[110:111], v[114:115], v[40:41] op_sel:[1,0] op_sel_hi:[1,1]
v_lshlrev_b32 v112, 16, v132
v_and_b32 v113, s72, v132
v_pk_fma_f32 v[96:97], v[112:113], v[42:43], v[96:97] op_sel:[0,0,0] op_sel_hi:[0,1,1]
v_pk_fma_f32 v[98:99], v[112:113], v[42:43], v[98:99] op_sel:[1,0,0] op_sel_hi:[1,1,1]
v_lshlrev_b32 v114, 16, v133
v_and_b32 v115, s72, v133
v_pk_fma_f32 v[100:101], v[114:115], v[42:43], v[100:101] op_sel:[0,0,0] op_sel_hi:[0,1,1]
v_pk_fma_f32 v[102:103], v[114:115], v[42:43], v[102:103] op_sel:[1,0,0] op_sel_hi:[1,1,1]
v_lshlrev_b32 v112, 16, v134
v_and_b32 v113, s72, v134
v_pk_fma_f32 v[104:105], v[112:113], v[42:43], v[104:105] op_sel:[0,0,0] op_sel_hi:[0,1,1]
v_pk_fma_f32 v[106:107], v[112:113], v[42:43], v[106:107] op_sel:[1,0,0] op_sel_hi:[1,1,1]
v_lshlrev_b32 v114, 16, v135
v_and_b32 v115, s72, v135
v_pk_fma_f32 v[108:109], v[114:115], v[42:43], v[108:109] op_sel:[0,0,0] op_sel_hi:[0,1,1]
v_pk_fma_f32 v[110:111], v[114:115], v[42:43], v[110:111] op_sel:[1,0,0] op_sel_hi:[1,1,1]
v_lshlrev_b32 v112, 16, v136
v_and_b32 v113, s72, v136
v_pk_fma_f32 v[96:97], v[112:113], v[44:45], v[96:97] op_sel:[0,0,0] op_sel_hi:[0,1,1]
v_pk_fma_f32 v[98:99], v[112:113], v[44:45], v[98:99] op_sel:[1,0,0] op_sel_hi:[1,1,1]
v_lshlrev_b32 v114, 16, v137
v_and_b32 v115, s72, v137
v_pk_fma_f32 v[100:101], v[114:115], v[44:45], v[100:101] op_sel:[0,0,0] op_sel_hi:[0,1,1]
v_pk_fma_f32 v[102:103], v[114:115], v[44:45], v[102:103] op_sel:[1,0,0] op_sel_hi:[1,1,1]
v_lshlrev_b32 v112, 16, v138
v_and_b32 v113, s72, v138
v_pk_fma_f32 v[104:105], v[112:113], v[44:45], v[104:105] op_sel:[0,0,0] op_sel_hi:[0,1,1]
v_pk_fma_f32 v[106:107], v[112:113], v[44:45], v[106:107] op_sel:[1,0,0] op_sel_hi:[1,1,1]
v_lshlrev_b32 v114, 16, v139
v_and_b32 v115, s72, v139
v_pk_fma_f32 v[108:109], v[114:115], v[44:45], v[108:109] op_sel:[0,0,0] op_sel_hi:[0,1,1]
v_pk_fma_f32 v[110:111], v[114:115], v[44:45], v[110:111] op_sel:[1,0,0] op_sel_hi:[1,1,1]
v_lshlrev_b32 v112, 16, v140
v_and_b32 v113, s72, v140
v_pk_fma_f32 v[96:97], v[112:113], v[46:47], v[96:97] op_sel:[0,0,0] op_sel_hi:[0,1,1]
v_pk_fma_f32 v[98:99], v[112:113], v[46:47], v[98:99] op_sel:[1,0,0] op_sel_hi:[1,1,1]
v_lshlrev_b32 v114, 16, v141
v_and_b32 v115, s72, v141
v_pk_fma_f32 v[100:101], v[114:115], v[46:47], v[100:101] op_sel:[0,0,0] op_sel_hi:[0,1,1]
v_pk_fma_f32 v[102:103], v[114:115], v[46:47], v[102:103] op_sel:[1,0,0] op_sel_hi:[1,1,1]
v_lshlrev_b32 v112, 16, v142
v_and_b32 v113, s72, v142
v_pk_fma_f32 v[104:105], v[112:113], v[46:47], v[104:105] op_sel:[0,0,0] op_sel_hi:[0,1,1]
v_pk_fma_f32 v[106:107], v[112:113], v[46:47], v[106:107] op_sel:[1,0,0] op_sel_hi:[1,1,1]
v_lshlrev_b32 v114, 16, v143
v_and_b32 v115, s72, v143
v_pk_fma_f32 v[108:109], v[114:115], v[46:47], v[108:109] op_sel:[0,0,0] op_sel_hi:[0,1,1]
v_pk_fma_f32 v[110:111], v[114:115], v[46:47], v[110:111] op_sel:[1,0,0] op_sel_hi:[1,1,1]
v_lshlrev_b32 v112, 16, v144
v_and_b32 v113, s72, v144
v_pk_fma_f32 v[96:97], v[112:113], v[48:49], v[96:97] op_sel:[0,0,0] op_sel_hi:[0,1,1]
v_pk_fma_f32 v[98:99], v[112:113], v[48:49], v[98:99] op_sel:[1,0,0] op_sel_hi:[1,1,1]
v_lshlrev_b32 v114, 16, v145
v_and_b32 v115, s72, v145
v_pk_fma_f32 v[100:101], v[114:115], v[48:49], v[100:101] op_sel:[0,0,0] op_sel_hi:[0,1,1]
v_pk_fma_f32 v[102:103], v[114:115], v[48:49], v[102:103] op_sel:[1,0,0] op_sel_hi:[1,1,1]
v_lshlrev_b32 v112, 16, v146
v_and_b32 v113, s72, v146
v_pk_fma_f32 v[104:105], v[112:113], v[48:49], v[104:105] op_sel:[0,0,0] op_sel_hi:[0,1,1]
v_pk_fma_f32 v[106:107], v[112:113], v[48:49], v[106:107] op_sel:[1,0,0] op_sel_hi:[1,1,1]
v_lshlrev_b32 v114, 16, v147
v_and_b32 v115, s72, v147
v_pk_fma_f32 v[108:109], v[114:115], v[48:49], v[108:109] op_sel:[0,0,0] op_sel_hi:[0,1,1]
v_pk_fma_f32 v[110:111], v[114:115], v[48:49], v[110:111] op_sel:[1,0,0] op_sel_hi:[1,1,1]
v_lshlrev_b32 v112, 16, v148
v_and_b32 v113, s72, v148
v_pk_fma_f32 v[96:97], v[112:113], v[50:51], v[96:97] op_sel:[0,0,0] op_sel_hi:[0,1,1]
v_pk_fma_f32 v[98:99], v[112:113], v[50:51], v[98:99] op_sel:[1,0,0] op_sel_hi:[1,1,1]
v_lshlrev_b32 v114, 16, v149
v_and_b32 v115, s72, v149
v_pk_fma_f32 v[100:101], v[114:115], v[50:51], v[100:101] op_sel:[0,0,0] op_sel_hi:[0,1,1]
v_pk_fma_f32 v[102:103], v[114:115], v[50:51], v[102:103] op_sel:[1,0,0] op_sel_hi:[1,1,1]
v_lshlrev_b32 v112, 16, v150
v_and_b32 v113, s72, v150
v_pk_fma_f32 v[104:105], v[112:113], v[50:51], v[104:105] op_sel:[0,0,0] op_sel_hi:[0,1,1]
v_pk_fma_f32 v[106:107], v[112:113], v[50:51], v[106:107] op_sel:[1,0,0] op_sel_hi:[1,1,1]
v_lshlrev_b32 v114, 16, v151
v_and_b32 v115, s72, v151
v_pk_fma_f32 v[108:109], v[114:115], v[50:51], v[108:109] op_sel:[0,0,0] op_sel_hi:[0,1,1]
v_pk_fma_f32 v[110:111], v[114:115], v[50:51], v[110:111] op_sel:[1,0,0] op_sel_hi:[1,1,1]
v_lshlrev_b32 v112, 16, v152
v_and_b32 v113, s72, v152
v_pk_fma_f32 v[96:97], v[112:113], v[52:53], v[96:97] op_sel:[0,0,0] op_sel_hi:[0,1,1]
v_pk_fma_f32 v[98:99], v[112:113], v[52:53], v[98:99] op_sel:[1,0,0] op_sel_hi:[1,1,1]
v_lshlrev_b32 v114, 16, v153
v_and_b32 v115, s72, v153
v_pk_fma_f32 v[100:101], v[114:115], v[52:53], v[100:101] op_sel:[0,0,0] op_sel_hi:[0,1,1]
v_pk_fma_f32 v[102:103], v[114:115], v[52:53], v[102:103] op_sel:[1,0,0] op_sel_hi:[1,1,1]
v_lshlrev_b32 v112, 16, v154
v_and_b32 v113, s72, v154
v_pk_fma_f32 v[104:105], v[112:113], v[52:53], v[104:105] op_sel:[0,0,0] op_sel_hi:[0,1,1]
v_pk_fma_f32 v[106:107], v[112:113], v[52:53], v[106:107] op_sel:[1,0,0] op_sel_hi:[1,1,1]
v_lshlrev_b32 v114, 16, v155
v_and_b32 v115, s72, v155
v_pk_fma_f32 v[108:109], v[114:115], v[52:53], v[108:109] op_sel:[0,0,0] op_sel_hi:[0,1,1]
v_pk_fma_f32 v[110:111], v[114:115], v[52:53], v[110:111] op_sel:[1,0,0] op_sel_hi:[1,1,1]
v_lshlrev_b32 v112, 16, v156
v_and_b32 v113, s72, v156
v_pk_fma_f32 v[96:97], v[112:113], v[54:55], v[96:97] op_sel:[0,0,0] op_sel_hi:[0,1,1]
v_pk_fma_f32 v[98:99], v[112:113], v[54:55], v[98:99] op_sel:[1,0,0] op_sel_hi:[1,1,1]
v_lshlrev_b32 v114, 16, v157
v_and_b32 v115, s72, v157
v_pk_fma_f32 v[100:101], v[114:115], v[54:55], v[100:101] op_sel:[0,0,0] op_sel_hi:[0,1,1]
v_pk_fma_f32 v[102:103], v[114:115], v[54:55], v[102:103] op_sel:[1,0,0] op_sel_hi:[1,1,1]
v_lshlrev_b32 v112, 16, v158
v_and_b32 v113, s72, v158
v_pk_fma_f32 v[104:105], v[112:113], v[54:55], v[104:105] op_sel:[0,0,0] op_sel_hi:[0,1,1]
v_pk_fma_f32 v[106:107], v[112:113], v[54:55], v[106:107] op_sel:[1,0,0] op_sel_hi:[1,1,1]
v_lshlrev_b32 v114, 16, v159
v_and_b32 v115, s72, v159
v_pk_fma_f32 v[108:109], v[114:115], v[54:55], v[108:109] op_sel:[0,0,0] op_sel_hi:[0,1,1]
v_pk_fma_f32 v[110:111], v[114:115], v[54:55], v[110:111] op_sel:[1,0,0] op_sel_hi:[1,1,1]
v_permlane32_swap_b32 v96, v104
v_permlane32_swap_b32 v97, v105
v_permlane32_swap_b32 v98, v106
v_permlane32_swap_b32 v99, v107
v_permlane32_swap_b32 v100, v108
v_permlane32_swap_b32 v101, v109
v_permlane32_swap_b32 v102, v110
v_permlane32_swap_b32 v103, v111
v_pk_add_f32 v[96:97], v[96:97], v[104:105]
v_pk_add_f32 v[98:99], v[98:99], v[106:107]
v_pk_add_f32 v[100:101], v[100:101], v[108:109]
v_pk_add_f32 v[102:103], v[102:103], v[110:111]
    s_nop 0
v_permlane16_swap_b32 v96, v100
v_permlane16_swap_b32 v97, v101
v_permlane16_swap_b32 v98, v102
v_permlane16_swap_b32 v99, v103
v_pk_add_f32 v[96:97], v[96:97], v[100:101]
v_pk_add_f32 v[98:99], v[98:99], v[102:103]
    s_nop 0
v_add_f32_dpp v96, v96, v96 row_ror:8 row_mask:0xf bank_mask:0xf
v_add_f32_dpp v97, v97, v97 row_ror:8 row_mask:0xf bank_mask:0xf
v_add_f32_dpp v98, v98, v98 row_ror:8 row_mask:0xf bank_mask:0xf
v_add_f32_dpp v99, v99, v99 row_ror:8 row_mask:0xf bank_mask:0xf
v_swap_b32 v97, v98
s_mov_b32 exec_lo, 0x00ff00ff
s_mov_b32 exec_hi, 0x00ff00ff
ds_write_b64 v14, v[96:97] offset:2560
ds_write_b64 v14, v[98:99] offset:2816
s_mov_b64 exec, -1
s_mov_b32 s74, 8192
buffer_load_dwordx4 a[32:35], v6, s[44:47], s74 offen offset:0 nt
buffer_load_dwordx4 a[36:39], v6, s[44:47], s74 offen offset:128 nt
buffer_load_dwordx4 a[40:43], v6, s[44:47], s74 offen offset:512 nt
buffer_load_dwordx4 a[44:47], v6, s[44:47], s74 offen offset:640 nt
buffer_load_dwordx4 a[48:51], v7, s[44:47], s74 offen offset:0 nt
buffer_load_dwordx4 a[52:55], v7, s[44:47], s74 offen offset:128 nt
buffer_load_dwordx4 a[56:59], v7, s[44:47], s74 offen offset:512 nt
buffer_load_dwordx4 a[60:63], v7, s[44:47], s74 offen offset:640 nt
s_waitcnt vmcnt(28)
v_lshlrev_b32 v112, 16, v160
v_and_b32 v113, s72, v160
v_pk_mul_f32 v[96:97], v[112:113], v[40:41] op_sel:[0,0] op_sel_hi:[0,1]
v_pk_mul_f32 v[98:99], v[112:113], v[40:41] op_sel:[1,0] op_sel_hi:[1,1]
v_lshlrev_b32 v114, 16, v161
v_and_b32 v115, s72, v161
v_pk_mul_f32 v[100:101], v[114:115], v[40:41] op_sel:[0,0] op_sel_hi:[0,1]
v_pk_mul_f32 v[102:103], v[114:115], v[40:41] op_sel:[1,0] op_sel_hi:[1,1]
v_lshlrev_b32 v112, 16, v162
v_and_b32 v113, s72, v162
v_pk_mul_f32 v[104:105], v[112:113], v[40:41] op_sel:[0,0] op_sel_hi:[0,1]
v_pk_mul_f32 v[106:107], v[112:113], v[40:41] op_sel:[1,0] op_sel_hi:[1,1]
v_lshlrev_b32 v114, 16, v163
v_and_b32 v115, s72, v163
v_pk_mul_f32 v[108:109], v[114:115], v[40:41] op_sel:[0,0] op_sel_hi:[0,1]
v_pk_mul_f32 v[110:111], v[114:115], v[40:41] op_sel:[1,0] op_sel_hi:[1,1]
v_lshlrev_b32 v112, 16, v164
v_and_b32 v113, s72, v164
v_pk_fma_f32 v[96:97], v[112:113], v[42:43], v[96:97] op_sel:[0,0,0] op_sel_hi:[0,1,1]
v_pk_fma_f32 v[98:99], v[112:113], v[42:43], v[98:99] op_sel:[1,0,0] op_sel_hi:[1,1,1]
v_lshlrev_b32 v114, 16, v165
v_and_b32 v115, s72, v165
v_pk_fma_f32 v[100:101], v[114:115], v[42:43], v[100:101] op_sel:[0,0,0] op_sel_hi:[0,1,1]
v_pk_fma_f32 v[102:103], v[114:115], v[42:43], v[102:103] op_sel:[1,0,0] op_sel_hi:[1,1,1]
v_lshlrev_b32 v112, 16, v166
v_and_b32 v113, s72, v166
v_pk_fma_f32 v[104:105], v[112:113], v[42:43], v[104:105] op_sel:[0,0,0] op_sel_hi:[0,1,1]
v_pk_fma_f32 v[106:107], v[112:113], v[42:43], v[106:107] op_sel:[1,0,0] op_sel_hi:[1,1,1]
v_lshlrev_b32 v114, 16, v167
v_and_b32 v115, s72, v167
v_pk_fma_f32 v[108:109], v[114:115], v[42:43], v[108:109] op_sel:[0,0,0] op_sel_hi:[0,1,1]
v_pk_fma_f32 v[110:111], v[114:115], v[42:43], v[110:111] op_sel:[1,0,0] op_sel_hi:[1,1,1]
v_lshlrev_b32 v112, 16, v168
v_and_b32 v113, s72, v168
v_pk_fma_f32 v[96:97], v[112:113], v[44:45], v[96:97] op_sel:[0,0,0] op_sel_hi:[0,1,1]
v_pk_fma_f32 v[98:99], v[112:113], v[44:45], v[98:99] op_sel:[1,0,0] op_sel_hi:[1,1,1]
v_lshlrev_b32 v114, 16, v169
v_and_b32 v115, s72, v169
v_pk_fma_f32 v[100:101], v[114:115], v[44:45], v[100:101] op_sel:[0,0,0] op_sel_hi:[0,1,1]
v_pk_fma_f32 v[102:103], v[114:115], v[44:45], v[102:103] op_sel:[1,0,0] op_sel_hi:[1,1,1]
v_lshlrev_b32 v112, 16, v170
v_and_b32 v113, s72, v170
v_pk_fma_f32 v[104:105], v[112:113], v[44:45], v[104:105] op_sel:[0,0,0] op_sel_hi:[0,1,1]
v_pk_fma_f32 v[106:107], v[112:113], v[44:45], v[106:107] op_sel:[1,0,0] op_sel_hi:[1,1,1]
v_lshlrev_b32 v114, 16, v171
v_and_b32 v115, s72, v171
v_pk_fma_f32 v[108:109], v[114:115], v[44:45], v[108:109] op_sel:[0,0,0] op_sel_hi:[0,1,1]
v_pk_fma_f32 v[110:111], v[114:115], v[44:45], v[110:111] op_sel:[1,0,0] op_sel_hi:[1,1,1]
v_lshlrev_b32 v112, 16, v172
v_and_b32 v113, s72, v172
v_pk_fma_f32 v[96:97], v[112:113], v[46:47], v[96:97] op_sel:[0,0,0] op_sel_hi:[0,1,1]
v_pk_fma_f32 v[98:99], v[112:113], v[46:47], v[98:99] op_sel:[1,0,0] op_sel_hi:[1,1,1]
v_lshlrev_b32 v114, 16, v173
v_and_b32 v115, s72, v173
v_pk_fma_f32 v[100:101], v[114:115], v[46:47], v[100:101] op_sel:[0,0,0] op_sel_hi:[0,1,1]
v_pk_fma_f32 v[102:103], v[114:115], v[46:47], v[102:103] op_sel:[1,0,0] op_sel_hi:[1,1,1]
v_lshlrev_b32 v112, 16, v174
v_and_b32 v113, s72, v174
v_pk_fma_f32 v[104:105], v[112:113], v[46:47], v[104:105] op_sel:[0,0,0] op_sel_hi:[0,1,1]
v_pk_fma_f32 v[106:107], v[112:113], v[46:47], v[106:107] op_sel:[1,0,0] op_sel_hi:[1,1,1]
v_lshlrev_b32 v114, 16, v175
v_and_b32 v115, s72, v175
v_pk_fma_f32 v[108:109], v[114:115], v[46:47], v[108:109] op_sel:[0,0,0] op_sel_hi:[0,1,1]
v_pk_fma_f32 v[110:111], v[114:115], v[46:47], v[110:111] op_sel:[1,0,0] op_sel_hi:[1,1,1]
v_lshlrev_b32 v112, 16, v176
v_and_b32 v113, s72, v176
v_pk_fma_f32 v[96:97], v[112:113], v[48:49], v[96:97] op_sel:[0,0,0] op_sel_hi:[0,1,1]
v_pk_fma_f32 v[98:99], v[112:113], v[48:49], v[98:99] op_sel:[1,0,0] op_sel_hi:[1,1,1]
v_lshlrev_b32 v114, 16, v177
v_and_b32 v115, s72, v177
v_pk_fma_f32 v[100:101], v[114:115], v[48:49], v[100:101] op_sel:[0,0,0] op_sel_hi:[0,1,1]
v_pk_fma_f32 v[102:103], v[114:115], v[48:49], v[102:103] op_sel:[1,0,0] op_sel_hi:[1,1,1]
v_lshlrev_b32 v112, 16, v178
v_and_b32 v113, s72, v178
v_pk_fma_f32 v[104:105], v[112:113], v[48:49], v[104:105] op_sel:[0,0,0] op_sel_hi:[0,1,1]
v_pk_fma_f32 v[106:107], v[112:113], v[48:49], v[106:107] op_sel:[1,0,0] op_sel_hi:[1,1,1]
v_lshlrev_b32 v114, 16, v179
v_and_b32 v115, s72, v179
v_pk_fma_f32 v[108:109], v[114:115], v[48:49], v[108:109] op_sel:[0,0,0] op_sel_hi:[0,1,1]
v_pk_fma_f32 v[110:111], v[114:115], v[48:49], v[110:111] op_sel:[1,0,0] op_sel_hi:[1,1,1]
v_lshlrev_b32 v112, 16, v180
v_and_b32 v113, s72, v180
v_pk_fma_f32 v[96:97], v[112:113], v[50:51], v[96:97] op_sel:[0,0,0] op_sel_hi:[0,1,1]
v_pk_fma_f32 v[98:99], v[112:113], v[50:51], v[98:99] op_sel:[1,0,0] op_sel_hi:[1,1,1]
v_lshlrev_b32 v114, 16, v181
v_and_b32 v115, s72, v181
v_pk_fma_f32 v[100:101], v[114:115], v[50:51], v[100:101] op_sel:[0,0,0] op_sel_hi:[0,1,1]
v_pk_fma_f32 v[102:103], v[114:115], v[50:51], v[102:103] op_sel:[1,0,0] op_sel_hi:[1,1,1]
v_lshlrev_b32 v112, 16, v182
v_and_b32 v113, s72, v182
v_pk_fma_f32 v[104:105], v[112:113], v[50:51], v[104:105] op_sel:[0,0,0] op_sel_hi:[0,1,1]
v_pk_fma_f32 v[106:107], v[112:113], v[50:51], v[106:107] op_sel:[1,0,0] op_sel_hi:[1,1,1]
v_lshlrev_b32 v114, 16, v183
v_and_b32 v115, s72, v183
v_pk_fma_f32 v[108:109], v[114:115], v[50:51], v[108:109] op_sel:[0,0,0] op_sel_hi:[0,1,1]
v_pk_fma_f32 v[110:111], v[114:115], v[50:51], v[110:111] op_sel:[1,0,0] op_sel_hi:[1,1,1]
v_lshlrev_b32 v112, 16, v184
v_and_b32 v113, s72, v184
v_pk_fma_f32 v[96:97], v[112:113], v[52:53], v[96:97] op_sel:[0,0,0] op_sel_hi:[0,1,1]
v_pk_fma_f32 v[98:99], v[112:113], v[52:53], v[98:99] op_sel:[1,0,0] op_sel_hi:[1,1,1]
v_lshlrev_b32 v114, 16, v185
v_and_b32 v115, s72, v185
v_pk_fma_f32 v[100:101], v[114:115], v[52:53], v[100:101] op_sel:[0,0,0] op_sel_hi:[0,1,1]
v_pk_fma_f32 v[102:103], v[114:115], v[52:53], v[102:103] op_sel:[1,0,0] op_sel_hi:[1,1,1]
v_lshlrev_b32 v112, 16, v186
v_and_b32 v113, s72, v186
v_pk_fma_f32 v[104:105], v[112:113], v[52:53], v[104:105] op_sel:[0,0,0] op_sel_hi:[0,1,1]
v_pk_fma_f32 v[106:107], v[112:113], v[52:53], v[106:107] op_sel:[1,0,0] op_sel_hi:[1,1,1]
v_lshlrev_b32 v114, 16, v187
v_and_b32 v115, s72, v187
v_pk_fma_f32 v[108:109], v[114:115], v[52:53], v[108:109] op_sel:[0,0,0] op_sel_hi:[0,1,1]
v_pk_fma_f32 v[110:111], v[114:115], v[52:53], v[110:111] op_sel:[1,0,0] op_sel_hi:[1,1,1]
v_lshlrev_b32 v112, 16, v188
v_and_b32 v113, s72, v188
v_pk_fma_f32 v[96:97], v[112:113], v[54:55], v[96:97] op_sel:[0,0,0] op_sel_hi:[0,1,1]
v_pk_fma_f32 v[98:99], v[112:113], v[54:55], v[98:99] op_sel:[1,0,0] op_sel_hi:[1,1,1]
v_lshlrev_b32 v114, 16, v189
v_and_b32 v115, s72, v189
v_pk_fma_f32 v[100:101], v[114:115], v[54:55], v[100:101] op_sel:[0,0,0] op_sel_hi:[0,1,1]
v_pk_fma_f32 v[102:103], v[114:115], v[54:55], v[102:103] op_sel:[1,0,0] op_sel_hi:[1,1,1]
v_lshlrev_b32 v112, 16, v190
v_and_b32 v113, s72, v190
v_pk_fma_f32 v[104:105], v[112:113], v[54:55], v[104:105] op_sel:[0,0,0] op_sel_hi:[0,1,1]
v_pk_fma_f32 v[106:107], v[112:113], v[54:55], v[106:107] op_sel:[1,0,0] op_sel_hi:[1,1,1]
v_lshlrev_b32 v114, 16, v191
v_and_b32 v115, s72, v191
v_pk_fma_f32 v[108:109], v[114:115], v[54:55], v[108:109] op_sel:[0,0,0] op_sel_hi:[0,1,1]
v_pk_fma_f32 v[110:111], v[114:115], v[54:55], v[110:111] op_sel:[1,0,0] op_sel_hi:[1,1,1]
v_permlane32_swap_b32 v96, v104
v_permlane32_swap_b32 v97, v105
v_permlane32_swap_b32 v98, v106
v_permlane32_swap_b32 v99, v107
v_permlane32_swap_b32 v100, v108
v_permlane32_swap_b32 v101, v109
v_permlane32_swap_b32 v102, v110
v_permlane32_swap_b32 v103, v111
v_pk_add_f32 v[96:97], v[96:97], v[104:105]
v_pk_add_f32 v[98:99], v[98:99], v[106:107]
v_pk_add_f32 v[100:101], v[100:101], v[108:109]
v_pk_add_f32 v[102:103], v[102:103], v[110:111]
    s_nop 0
v_permlane16_swap_b32 v96, v100
v_permlane16_swap_b32 v97, v101
v_permlane16_swap_b32 v98, v102
v_permlane16_swap_b32 v99, v103
v_pk_add_f32 v[96:97], v[96:97], v[100:101]
v_pk_add_f32 v[98:99], v[98:99], v[102:103]
    s_nop 0
v_add_f32_dpp v96, v96, v96 row_ror:8 row_mask:0xf bank_mask:0xf
v_add_f32_dpp v97, v97, v97 row_ror:8 row_mask:0xf bank_mask:0xf
v_add_f32_dpp v98, v98, v98 row_ror:8 row_mask:0xf bank_mask:0xf
v_add_f32_dpp v99, v99, v99 row_ror:8 row_mask:0xf bank_mask:0xf
v_swap_b32 v97, v98
s_mov_b32 exec_lo, 0x00ff00ff
s_mov_b32 exec_hi, 0x00ff00ff
ds_write_b64 v14, v[96:97] offset:4608
ds_write_b64 v14, v[98:99] offset:4864
s_mov_b64 exec, -1
s_waitcnt vmcnt(20)
v_lshlrev_b32 v112, 16, v192
v_and_b32 v113, s72, v192
v_pk_mul_f32 v[96:97], v[112:113], v[40:41] op_sel:[0,0] op_sel_hi:[0,1]
v_pk_mul_f32 v[98:99], v[112:113], v[40:41] op_sel:[1,0] op_sel_hi:[1,1]
v_lshlrev_b32 v114, 16, v193
v_and_b32 v115, s72, v193
v_pk_mul_f32 v[100:101], v[114:115], v[40:41] op_sel:[0,0] op_sel_hi:[0,1]
v_pk_mul_f32 v[102:103], v[114:115], v[40:41] op_sel:[1,0] op_sel_hi:[1,1]
v_lshlrev_b32 v112, 16, v194
v_and_b32 v113, s72, v194
v_pk_mul_f32 v[104:105], v[112:113], v[40:41] op_sel:[0,0] op_sel_hi:[0,1]
v_pk_mul_f32 v[106:107], v[112:113], v[40:41] op_sel:[1,0] op_sel_hi:[1,1]
v_lshlrev_b32 v114, 16, v195
v_and_b32 v115, s72, v195
v_pk_mul_f32 v[108:109], v[114:115], v[40:41] op_sel:[0,0] op_sel_hi:[0,1]
v_pk_mul_f32 v[110:111], v[114:115], v[40:41] op_sel:[1,0] op_sel_hi:[1,1]
v_lshlrev_b32 v112, 16, v196
v_and_b32 v113, s72, v196
v_pk_fma_f32 v[96:97], v[112:113], v[42:43], v[96:97] op_sel:[0,0,0] op_sel_hi:[0,1,1]
v_pk_fma_f32 v[98:99], v[112:113], v[42:43], v[98:99] op_sel:[1,0,0] op_sel_hi:[1,1,1]
v_lshlrev_b32 v114, 16, v197
v_and_b32 v115, s72, v197
v_pk_fma_f32 v[100:101], v[114:115], v[42:43], v[100:101] op_sel:[0,0,0] op_sel_hi:[0,1,1]
v_pk_fma_f32 v[102:103], v[114:115], v[42:43], v[102:103] op_sel:[1,0,0] op_sel_hi:[1,1,1]
v_lshlrev_b32 v112, 16, v198
v_and_b32 v113, s72, v198
v_pk_fma_f32 v[104:105], v[112:113], v[42:43], v[104:105] op_sel:[0,0,0] op_sel_hi:[0,1,1]
v_pk_fma_f32 v[106:107], v[112:113], v[42:43], v[106:107] op_sel:[1,0,0] op_sel_hi:[1,1,1]
v_lshlrev_b32 v114, 16, v199
v_and_b32 v115, s72, v199
v_pk_fma_f32 v[108:109], v[114:115], v[42:43], v[108:109] op_sel:[0,0,0] op_sel_hi:[0,1,1]
v_pk_fma_f32 v[110:111], v[114:115], v[42:43], v[110:111] op_sel:[1,0,0] op_sel_hi:[1,1,1]
v_lshlrev_b32 v112, 16, v200
v_and_b32 v113, s72, v200
v_pk_fma_f32 v[96:97], v[112:113], v[44:45], v[96:97] op_sel:[0,0,0] op_sel_hi:[0,1,1]
v_pk_fma_f32 v[98:99], v[112:113], v[44:45], v[98:99] op_sel:[1,0,0] op_sel_hi:[1,1,1]
v_lshlrev_b32 v114, 16, v201
v_and_b32 v115, s72, v201
v_pk_fma_f32 v[100:101], v[114:115], v[44:45], v[100:101] op_sel:[0,0,0] op_sel_hi:[0,1,1]
v_pk_fma_f32 v[102:103], v[114:115], v[44:45], v[102:103] op_sel:[1,0,0] op_sel_hi:[1,1,1]
v_lshlrev_b32 v112, 16, v202
v_and_b32 v113, s72, v202
v_pk_fma_f32 v[104:105], v[112:113], v[44:45], v[104:105] op_sel:[0,0,0] op_sel_hi:[0,1,1]
v_pk_fma_f32 v[106:107], v[112:113], v[44:45], v[106:107] op_sel:[1,0,0] op_sel_hi:[1,1,1]
v_lshlrev_b32 v114, 16, v203
v_and_b32 v115, s72, v203
v_pk_fma_f32 v[108:109], v[114:115], v[44:45], v[108:109] op_sel:[0,0,0] op_sel_hi:[0,1,1]
v_pk_fma_f32 v[110:111], v[114:115], v[44:45], v[110:111] op_sel:[1,0,0] op_sel_hi:[1,1,1]
v_lshlrev_b32 v112, 16, v204
v_and_b32 v113, s72, v204
v_pk_fma_f32 v[96:97], v[112:113], v[46:47], v[96:97] op_sel:[0,0,0] op_sel_hi:[0,1,1]
v_pk_fma_f32 v[98:99], v[112:113], v[46:47], v[98:99] op_sel:[1,0,0] op_sel_hi:[1,1,1]
v_lshlrev_b32 v114, 16, v205
v_and_b32 v115, s72, v205
v_pk_fma_f32 v[100:101], v[114:115], v[46:47], v[100:101] op_sel:[0,0,0] op_sel_hi:[0,1,1]
v_pk_fma_f32 v[102:103], v[114:115], v[46:47], v[102:103] op_sel:[1,0,0] op_sel_hi:[1,1,1]
v_lshlrev_b32 v112, 16, v206
v_and_b32 v113, s72, v206
v_pk_fma_f32 v[104:105], v[112:113], v[46:47], v[104:105] op_sel:[0,0,0] op_sel_hi:[0,1,1]
v_pk_fma_f32 v[106:107], v[112:113], v[46:47], v[106:107] op_sel:[1,0,0] op_sel_hi:[1,1,1]
v_lshlrev_b32 v114, 16, v207
v_and_b32 v115, s72, v207
v_pk_fma_f32 v[108:109], v[114:115], v[46:47], v[108:109] op_sel:[0,0,0] op_sel_hi:[0,1,1]
v_pk_fma_f32 v[110:111], v[114:115], v[46:47], v[110:111] op_sel:[1,0,0] op_sel_hi:[1,1,1]
v_lshlrev_b32 v112, 16, v208
v_and_b32 v113, s72, v208
v_pk_fma_f32 v[96:97], v[112:113], v[48:49], v[96:97] op_sel:[0,0,0] op_sel_hi:[0,1,1]
v_pk_fma_f32 v[98:99], v[112:113], v[48:49], v[98:99] op_sel:[1,0,0] op_sel_hi:[1,1,1]
v_lshlrev_b32 v114, 16, v209
v_and_b32 v115, s72, v209
v_pk_fma_f32 v[100:101], v[114:115], v[48:49], v[100:101] op_sel:[0,0,0] op_sel_hi:[0,1,1]
v_pk_fma_f32 v[102:103], v[114:115], v[48:49], v[102:103] op_sel:[1,0,0] op_sel_hi:[1,1,1]
v_lshlrev_b32 v112, 16, v210
v_and_b32 v113, s72, v210
v_pk_fma_f32 v[104:105], v[112:113], v[48:49], v[104:105] op_sel:[0,0,0] op_sel_hi:[0,1,1]
v_pk_fma_f32 v[106:107], v[112:113], v[48:49], v[106:107] op_sel:[1,0,0] op_sel_hi:[1,1,1]
v_lshlrev_b32 v114, 16, v211
v_and_b32 v115, s72, v211
v_pk_fma_f32 v[108:109], v[114:115], v[48:49], v[108:109] op_sel:[0,0,0] op_sel_hi:[0,1,1]
v_pk_fma_f32 v[110:111], v[114:115], v[48:49], v[110:111] op_sel:[1,0,0] op_sel_hi:[1,1,1]
v_lshlrev_b32 v112, 16, v212
v_and_b32 v113, s72, v212
v_pk_fma_f32 v[96:97], v[112:113], v[50:51], v[96:97] op_sel:[0,0,0] op_sel_hi:[0,1,1]
v_pk_fma_f32 v[98:99], v[112:113], v[50:51], v[98:99] op_sel:[1,0,0] op_sel_hi:[1,1,1]
v_lshlrev_b32 v114, 16, v213
v_and_b32 v115, s72, v213
v_pk_fma_f32 v[100:101], v[114:115], v[50:51], v[100:101] op_sel:[0,0,0] op_sel_hi:[0,1,1]
v_pk_fma_f32 v[102:103], v[114:115], v[50:51], v[102:103] op_sel:[1,0,0] op_sel_hi:[1,1,1]
v_lshlrev_b32 v112, 16, v214
v_and_b32 v113, s72, v214
v_pk_fma_f32 v[104:105], v[112:113], v[50:51], v[104:105] op_sel:[0,0,0] op_sel_hi:[0,1,1]
v_pk_fma_f32 v[106:107], v[112:113], v[50:51], v[106:107] op_sel:[1,0,0] op_sel_hi:[1,1,1]
v_lshlrev_b32 v114, 16, v215
v_and_b32 v115, s72, v215
v_pk_fma_f32 v[108:109], v[114:115], v[50:51], v[108:109] op_sel:[0,0,0] op_sel_hi:[0,1,1]
v_pk_fma_f32 v[110:111], v[114:115], v[50:51], v[110:111] op_sel:[1,0,0] op_sel_hi:[1,1,1]
v_lshlrev_b32 v112, 16, v216
v_and_b32 v113, s72, v216
v_pk_fma_f32 v[96:97], v[112:113], v[52:53], v[96:97] op_sel:[0,0,0] op_sel_hi:[0,1,1]
v_pk_fma_f32 v[98:99], v[112:113], v[52:53], v[98:99] op_sel:[1,0,0] op_sel_hi:[1,1,1]
v_lshlrev_b32 v114, 16, v217
v_and_b32 v115, s72, v217
v_pk_fma_f32 v[100:101], v[114:115], v[52:53], v[100:101] op_sel:[0,0,0] op_sel_hi:[0,1,1]
v_pk_fma_f32 v[102:103], v[114:115], v[52:53], v[102:103] op_sel:[1,0,0] op_sel_hi:[1,1,1]
v_lshlrev_b32 v112, 16, v218
v_and_b32 v113, s72, v218
v_pk_fma_f32 v[104:105], v[112:113], v[52:53], v[104:105] op_sel:[0,0,0] op_sel_hi:[0,1,1]
v_pk_fma_f32 v[106:107], v[112:113], v[52:53], v[106:107] op_sel:[1,0,0] op_sel_hi:[1,1,1]
v_lshlrev_b32 v114, 16, v219
v_and_b32 v115, s72, v219
v_pk_fma_f32 v[108:109], v[114:115], v[52:53], v[108:109] op_sel:[0,0,0] op_sel_hi:[0,1,1]
v_pk_fma_f32 v[110:111], v[114:115], v[52:53], v[110:111] op_sel:[1,0,0] op_sel_hi:[1,1,1]
v_lshlrev_b32 v112, 16, v220
v_and_b32 v113, s72, v220
v_pk_fma_f32 v[96:97], v[112:113], v[54:55], v[96:97] op_sel:[0,0,0] op_sel_hi:[0,1,1]
v_pk_fma_f32 v[98:99], v[112:113], v[54:55], v[98:99] op_sel:[1,0,0] op_sel_hi:[1,1,1]
v_lshlrev_b32 v114, 16, v221
v_and_b32 v115, s72, v221
v_pk_fma_f32 v[100:101], v[114:115], v[54:55], v[100:101] op_sel:[0,0,0] op_sel_hi:[0,1,1]
v_pk_fma_f32 v[102:103], v[114:115], v[54:55], v[102:103] op_sel:[1,0,0] op_sel_hi:[1,1,1]
v_lshlrev_b32 v112, 16, v222
v_and_b32 v113, s72, v222
v_pk_fma_f32 v[104:105], v[112:113], v[54:55], v[104:105] op_sel:[0,0,0] op_sel_hi:[0,1,1]
v_pk_fma_f32 v[106:107], v[112:113], v[54:55], v[106:107] op_sel:[1,0,0] op_sel_hi:[1,1,1]
v_lshlrev_b32 v114, 16, v223
v_and_b32 v115, s72, v223
v_pk_fma_f32 v[108:109], v[114:115], v[54:55], v[108:109] op_sel:[0,0,0] op_sel_hi:[0,1,1]
v_pk_fma_f32 v[110:111], v[114:115], v[54:55], v[110:111] op_sel:[1,0,0] op_sel_hi:[1,1,1]
v_permlane32_swap_b32 v96, v104
v_permlane32_swap_b32 v97, v105
v_permlane32_swap_b32 v98, v106
v_permlane32_swap_b32 v99, v107
v_permlane32_swap_b32 v100, v108
v_permlane32_swap_b32 v101, v109
v_permlane32_swap_b32 v102, v110
v_permlane32_swap_b32 v103, v111
v_pk_add_f32 v[96:97], v[96:97], v[104:105]
v_pk_add_f32 v[98:99], v[98:99], v[106:107]
v_pk_add_f32 v[100:101], v[100:101], v[108:109]
v_pk_add_f32 v[102:103], v[102:103], v[110:111]
    s_nop 0
v_permlane16_swap_b32 v96, v100
v_permlane16_swap_b32 v97, v101
v_permlane16_swap_b32 v98, v102
v_permlane16_swap_b32 v99, v103
v_pk_add_f32 v[96:97], v[96:97], v[100:101]
v_pk_add_f32 v[98:99], v[98:99], v[102:103]
    s_nop 0
v_add_f32_dpp v96, v96, v96 row_ror:8 row_mask:0xf bank_mask:0xf
v_add_f32_dpp v97, v97, v97 row_ror:8 row_mask:0xf bank_mask:0xf
v_add_f32_dpp v98, v98, v98 row_ror:8 row_mask:0xf bank_mask:0xf
v_add_f32_dpp v99, v99, v99 row_ror:8 row_mask:0xf bank_mask:0xf
v_swap_b32 v97, v98
s_mov_b32 exec_lo, 0x00ff00ff
s_mov_b32 exec_hi, 0x00ff00ff
ds_write_b64 v14, v[96:97] offset:6656
ds_write_b64 v14, v[98:99] offset:6912
s_mov_b64 exec, -1
s_waitcnt lgkmcnt(0)
s_barrier

    s_cmp_lg_u32 s3, 0
    s_cbranch_scc1 L_nopub
    v_lshrrev_b32 v11, 5, v1
    v_lshlrev_b32 v11, 11, v11
    v_bfe_u32 v12, v1, 4, 1
    v_lshlrev_b32 v13, 8, v12
    v_add_u32 v11, v11, v13
    v_and_b32 v14, 15, v1
    v_lshlrev_b32 v15, 4, v14
    v_add_u32 v11, v11, v15
    v_and_b32 v58, 0x7ff, v11

ds_read_b128 v[96:99], v11 offset:2560
ds_read_b128 v[100:103], v11 offset:3072
ds_read_b128 v[104:107], v11 offset:3584
ds_read_b128 v[108:111], v11 offset:4096
ds_read_b128 v[64:67], v58 offset:6656
ds_read_b128 v[68:71], v58 offset:7168
ds_read_b128 v[72:75], v58 offset:7680
ds_read_b128 v[76:79], v58 offset:8192

    v_lshlrev_b32 v59, 14, v12
    v_add_u32 v59, v59, v15
    s_lshl_b32 s73, s8, 15
    s_lshl_b32 s74, s7, 8
    s_add_u32 s73, s73, s74
    v_add_u32 v59, s73, v59
    v_lshrrev_b32 v60, 2, v14
    v_lshlrev_b32 v60, 10, v60
    v_lshlrev_b32 v61, 6, v12
    v_add_u32 v60, v60, v61
    v_and_b32 v61, 3, v14
    v_lshlrev_b32 v61, 4, v61
    v_add_u32 v60, v60, v61
    s_lshl_b32 s73, s7, 12
    s_lshl_b32 s74, s8, 8
    s_add_u32 s73, s73, s74
    s_add_u32 s73, s73, 131072
    s_xor_b32 s73, s73, 8192
    v_add_u32 v60, s73, v60
    v_cmp_gt_u32 vcc, 32, v1
    s_nop 1
    v_cndmask_b32 v59, v60, v59, vcc
    v_xor_b32 v60, 24576, v60
    v_add_u32 v60, 128, v60
    s_waitcnt lgkmcnt(4)
    v_pk_add_f32 v[96:97], v[96:97], v[100:101]
    v_pk_add_f32 v[98:99], v[98:99], v[102:103]
    v_pk_add_f32 v[104:105], v[104:105], v[108:109]
    v_pk_add_f32 v[106:107], v[106:107], v[110:111]
    v_pk_add_f32 v[96:97], v[96:97], v[104:105]
    v_pk_add_f32 v[98:99], v[98:99], v[106:107]

buffer_store_dwordx4 v[96:99], v59, s[60:63], 0 offen sc1

    s_waitcnt lgkmcnt(0)
    v_pk_add_f32 v[64:65], v[64:65], v[68:69]
    v_pk_add_f32 v[66:67], v[66:67], v[70:71]
    v_pk_add_f32 v[72:73], v[72:73], v[76:77]
    v_pk_add_f32 v[74:75], v[74:75], v[78:79]
    v_pk_add_f32 v[64:65], v[64:65], v[72:73]
    v_pk_add_f32 v[66:67], v[66:67], v[74:75]
    s_mov_b32 exec_hi, 0

buffer_store_dwordx4 v[64:67], v60, s[60:63], 0 offen sc1
s_mov_b64 exec, -1
L_nopub:
s_mov_b32 s74, 16384
buffer_load_dwordx4 a[64:67], v6, s[44:47], s74 offen offset:0 nt
buffer_load_dwordx4 a[68:71], v6, s[44:47], s74 offen offset:128 nt
buffer_load_dwordx4 a[72:75], v6, s[44:47], s74 offen offset:512 nt
buffer_load_dwordx4 a[76:79], v6, s[44:47], s74 offen offset:640 nt
buffer_load_dwordx4 a[80:83], v7, s[44:47], s74 offen offset:0 nt
buffer_load_dwordx4 a[84:87], v7, s[44:47], s74 offen offset:128 nt
buffer_load_dwordx4 a[88:91], v7, s[44:47], s74 offen offset:512 nt
buffer_load_dwordx4 a[92:95], v7, s[44:47], s74 offen offset:640 nt
s_waitcnt vmcnt(8)
s_barrier
s_cmp_lg_u32 s3, 0
s_cbranch_scc1 L_nosig

    v_mov_b32 v11, 1
    s_and_b32 s73, s2, 3
    s_lshl_b32 s73, s73, 6
    v_mov_b32 v12, s73
    s_mov_b64 exec, 1

buffer_atomic_add v11, v12, s[68:71], 0 offen sc1
s_mov_b64 exec, -1
L_nosig:
s_mov_b32 s74, 24576
buffer_load_dwordx4 a[96:99], v6, s[44:47], s74 offen offset:0 nt
buffer_load_dwordx4 a[100:103], v6, s[44:47], s74 offen offset:128 nt
buffer_load_dwordx4 a[104:107], v6, s[44:47], s74 offen offset:512 nt
buffer_load_dwordx4 a[108:111], v6, s[44:47], s74 offen offset:640 nt
buffer_load_dwordx4 a[112:115], v7, s[44:47], s74 offen offset:0 nt
buffer_load_dwordx4 a[116:119], v7, s[44:47], s74 offen offset:128 nt
buffer_load_dwordx4 a[120:123], v7, s[44:47], s74 offen offset:512 nt
buffer_load_dwordx4 a[124:127], v7, s[44:47], s74 offen offset:640 nt
s_waitcnt vmcnt(24)
s_mov_b32 s74, 32768
buffer_load_dwordx4 a[128:131], v6, s[44:47], s74 offen offset:0 nt
buffer_load_dwordx4 a[132:135], v6, s[44:47], s74 offen offset:128 nt
buffer_load_dwordx4 a[136:139], v6, s[44:47], s74 offen offset:512 nt
buffer_load_dwordx4 a[140:143], v6, s[44:47], s74 offen offset:640 nt
buffer_load_dwordx4 a[144:147], v7, s[44:47], s74 offen offset:0 nt
buffer_load_dwordx4 a[148:151], v7, s[44:47], s74 offen offset:128 nt
buffer_load_dwordx4 a[152:155], v7, s[44:47], s74 offen offset:512 nt
buffer_load_dwordx4 a[156:159], v7, s[44:47], s74 offen offset:640 nt
s_waitcnt vmcnt(24)
s_mov_b32 s74, 40960
buffer_load_dwordx4 a[160:163], v6, s[44:47], s74 offen offset:0 nt
buffer_load_dwordx4 a[164:167], v6, s[44:47], s74 offen offset:128 nt
buffer_load_dwordx4 a[168:171], v6, s[44:47], s74 offen offset:512 nt
buffer_load_dwordx4 a[172:175], v6, s[44:47], s74 offen offset:640 nt
buffer_load_dwordx4 a[176:179], v7, s[44:47], s74 offen offset:0 nt
buffer_load_dwordx4 a[180:183], v7, s[44:47], s74 offen offset:128 nt
buffer_load_dwordx4 a[184:187], v7, s[44:47], s74 offen offset:512 nt
buffer_load_dwordx4 a[188:191], v7, s[44:47], s74 offen offset:640 nt

    s_cmp_lg_u32 s3, 0
    s_cbranch_scc1 L_nopoll1
    v_and_b32 v40, 3, v1
    v_lshlrev_b32 v40, 6, v40

buffer_load_dword v41, v40, s[68:71], 0 offen sc1
L_nopoll1:
s_waitcnt vmcnt(24)
s_mov_b32 s74, 49152
buffer_load_dwordx4 a[192:195], v6, s[44:47], s74 offen offset:0 nt
buffer_load_dwordx4 a[196:199], v6, s[44:47], s74 offen offset:128 nt
buffer_load_dwordx4 a[200:203], v6, s[44:47], s74 offen offset:512 nt
buffer_load_dwordx4 a[204:207], v6, s[44:47], s74 offen offset:640 nt
buffer_load_dwordx4 a[208:211], v7, s[44:47], s74 offen offset:0 nt
buffer_load_dwordx4 a[212:215], v7, s[44:47], s74 offen offset:128 nt
buffer_load_dwordx4 a[216:219], v7, s[44:47], s74 offen offset:512 nt
buffer_load_dwordx4 a[220:223], v7, s[44:47], s74 offen offset:640 nt
s_cmp_lg_u32 s3, 0
s_cbranch_scc1 L_qok
s_waitcnt vmcnt(8)

    s_mov_b32 s75, 0
L_qspin:
    v_cmp_eq_u32 vcc, 64, v41
    s_nop 1
    s_cmp_eq_u64 vcc, -1
    s_cbranch_scc1 L_qok
    s_add_u32 s75, s75, 1
    s_cmp_gt_u32 s75, 20000
    s_cbranch_scc1 L_end
    buffer_load_dword v41, v40, s[68:71], 0 offen sc1
    s_waitcnt vmcnt(0)
    s_branch L_qspin
L_qok:
    s_barrier
    v_lshlrev_b32 v40, 4, v0
    s_lshl_b32 s73, s4, 14
    s_lshl_b32 s74, s5, 12
    s_add_u32 s73, s73, s74

buffer_load_dwordx4 v[16:19], v40, s[60:63], s73 offen sc1
s_add_u32 s73, s73, 32768
buffer_load_dwordx4 v[20:23], v40, s[60:63], s73 offen sc1
s_add_u32 s73, s73, 32768
buffer_load_dwordx4 v[24:27], v40, s[60:63], s73 offen sc1
s_add_u32 s73, s73, 32768
buffer_load_dwordx4 v[28:31], v40, s[60:63], s73 offen sc1

    v_lshlrev_b32 v41, 4, v1
    s_lshl_b32 s73, s0, 10
    s_add_u32 s73, s73, 131072

buffer_load_dwordx4 v[32:35], v41, s[60:63], s73 offen sc1
s_mov_b32 s74, 57344
buffer_load_dwordx4 a[224:227], v6, s[44:47], s74 offen offset:0 nt
buffer_load_dwordx4 a[228:231], v6, s[44:47], s74 offen offset:128 nt
buffer_load_dwordx4 a[232:235], v6, s[44:47], s74 offen offset:512 nt
buffer_load_dwordx4 a[236:239], v6, s[44:47], s74 offen offset:640 nt
buffer_load_dwordx4 a[240:243], v7, s[44:47], s74 offen offset:0 nt
buffer_load_dwordx4 a[244:247], v7, s[44:47], s74 offen offset:128 nt
buffer_load_dwordx4 a[248:251], v7, s[44:47], s74 offen offset:512 nt
buffer_load_dwordx4 a[252:255], v7, s[44:47], s74 offen offset:640 nt

    v_lshrrev_b32 v42, 5, v0
    v_lshlrev_b32 v42, 4, v42
    v_lshlrev_b32 v43, 3, v0
    v_add_u32 v42, v42, v43
    v_and_b32 v43, 7, v1
    v_mul_u32_u24 v43, 272, v43
    v_lshrrev_b32 v44, 4, v1
    v_lshlrev_b32 v44, 4, v44
    v_add_u32 v43, v43, v44
    v_bfe_u32 v44, v1, 3, 1
    v_lshlrev_b32 v44, 6, v44
    v_add_u32 v43, v43, v44
    v_and_b32 v44, 3, v1
    v_lshlrev_b32 v44, 5, v44
    v_lshrrev_b32 v45, 4, v1
    v_lshlrev_b32 v45, 3, v45
    v_add_u32 v44, v44, v45
    v_bfe_u32 v45, v1, 2, 1
    v_lshlrev_b32 v45, 2, v45
    v_add_u32 v44, v44, v45

s_waitcnt vmcnt(8)

    v_pk_add_f32 v[16:17], v[16:17], v[20:21]
    v_pk_add_f32 v[18:19], v[18:19], v[22:23]
    v_pk_add_f32 v[24:25], v[24:25], v[28:29]
    v_pk_add_f32 v[26:27], v[26:27], v[30:31]
    v_pk_add_f32 v[16:17], v[16:17], v[24:25]
    v_pk_add_f32 v[18:19], v[18:19], v[26:27]
    v_cvt_pk_bf16_f32 v16, v16, v17
    v_cvt_pk_bf16_f32 v17, v18, v19
    ds_write_b64 v42, v[16:17] offset:10752
    v_permlane32_swap_b32 v32, v34
    v_permlane32_swap_b32 v33, v35
    v_pk_add_f32 v[32:33], v[32:33], v[34:35]
    s_nop 1
    v_permlane16_swap_b32 v32, v33
    v_add_f32 v96, v32, v33

v_cvt_pk_bf16_f32 v96, v96, v96
v_and_b32 v96, s72, v96

    s_nop 1
    v_mov_b32_dpp v100, v96 row_ror:8 row_mask:0xf bank_mask:0xf
    v_mul_f32 v98, 0xbfb8aa3b, v96
    v_exp_f32 v98, v98
    s_nop 0
    v_add_f32 v98, 1.0, v98
    v_rcp_f32 v99, v98
    s_nop 0
    v_mul_f32 v101, v96, v99
    v_fma_f32 v102, -v101, v98, v96
    v_fma_f32 v102, v102, v99, v101
    v_cmp_eq_f32 vcc, 0x7f800000, v98
    s_nop 1
    v_cndmask_b32 v101, v102, v101, vcc

v_cvt_pk_bf16_f32 v101, v101, v101
v_and_b32 v101, s72, v101
v_mul_f32 v101, v101, v100
v_cvt_pk_bf16_f32 v101, v101, v101
v_and_b32 v101, s72, v101
s_mov_b32 exec_lo, 0x00ff00ff
s_mov_b32 exec_hi, 0x00ff00ff
ds_write_b32 v44, v101 offset:1536
s_mov_b64 exec, -1
v_mov_b32 v11, 0
s_waitcnt lgkmcnt(0)
s_barrier
ds_read_b128 v[16:19], v43 offset:10752
ds_read_b128 v[20:23], v43 offset:10880
s_mov_b32 s74, 0
buffer_load_dwordx4 v[128:131], v8, s[48:51], s74 offen offset:0 nt
buffer_load_dwordx4 v[132:135], v8, s[48:51], s74 offen offset:1024 nt
buffer_load_dwordx4 v[136:139], v8, s[48:51], s74 offen offset:2048 nt
buffer_load_dwordx4 v[140:143], v8, s[48:51], s74 offen offset:3072 nt
buffer_load_dwordx4 v[144:147], v9, s[48:51], s74 offen offset:0 nt
buffer_load_dwordx4 v[148:151], v9, s[48:51], s74 offen offset:1024 nt
buffer_load_dwordx4 v[152:155], v9, s[48:51], s74 offen offset:2048 nt
buffer_load_dwordx4 v[156:159], v9, s[48:51], s74 offen offset:3072 nt
s_waitcnt lgkmcnt(0)
s_mov_b32 s74, 8192
buffer_load_dwordx4 v[160:163], v8, s[48:51], s74 offen offset:0 nt
buffer_load_dwordx4 v[164:167], v8, s[48:51], s74 offen offset:1024 nt
buffer_load_dwordx4 v[168:171], v8, s[48:51], s74 offen offset:2048 nt
buffer_load_dwordx4 v[172:175], v8, s[48:51], s74 offen offset:3072 nt
buffer_load_dwordx4 v[176:179], v9, s[48:51], s74 offen offset:0 nt
buffer_load_dwordx4 v[180:183], v9, s[48:51], s74 offen offset:1024 nt
buffer_load_dwordx4 v[184:187], v9, s[48:51], s74 offen offset:2048 nt
buffer_load_dwordx4 v[188:191], v9, s[48:51], s74 offen offset:3072 nt
s_mov_b32 s10, 0x3db504f3
s_mov_b32 s11, 0x3db504f3
s_waitcnt vmcnt(16)
v_mfma_f32_16x16x32_bf16 v[64:67], a[0:3], v[16:19], 0
v_mfma_f32_16x16x32_bf16 v[24:27], a[8:11], v[16:19], 0
v_mfma_f32_16x16x32_bf16 v[68:71], a[16:19], v[16:19], 0
v_mfma_f32_16x16x32_bf16 v[28:31], a[24:27], v[16:19], 0
v_mfma_f32_16x16x32_bf16 v[64:67], a[4:7], v[20:23], v[64:67]
v_mfma_f32_16x16x32_bf16 v[24:27], a[12:15], v[20:23], v[24:27]
v_mfma_f32_16x16x32_bf16 v[68:71], a[20:23], v[20:23], v[68:71]
v_mfma_f32_16x16x32_bf16 v[28:31], a[28:31], v[20:23], v[28:31]
v_mfma_f32_16x16x32_bf16 v[72:75], a[32:35], v[16:19], 0
v_mfma_f32_16x16x32_bf16 v[32:35], a[40:43], v[16:19], 0
v_mfma_f32_16x16x32_bf16 v[76:79], a[48:51], v[16:19], 0
v_mfma_f32_16x16x32_bf16 v[36:39], a[56:59], v[16:19], 0
v_mfma_f32_16x16x32_bf16 v[72:75], a[36:39], v[20:23], v[72:75]
v_mfma_f32_16x16x32_bf16 v[32:35], a[44:47], v[20:23], v[32:35]
v_mfma_f32_16x16x32_bf16 v[76:79], a[52:55], v[20:23], v[76:79]
v_mfma_f32_16x16x32_bf16 v[36:39], a[60:63], v[20:23], v[36:39]
v_permlane32_swap_b32 v64, v24
v_permlane32_swap_b32 v65, v25
v_permlane32_swap_b32 v66, v26
v_permlane32_swap_b32 v67, v27
v_permlane32_swap_b32 v68, v28
v_permlane32_swap_b32 v69, v29
v_permlane32_swap_b32 v70, v30
v_permlane32_swap_b32 v71, v31
v_add_f32_dpp v64, v24, v64 row_ror:8 row_mask:0xf bank_mask:0xf
v_add_f32_dpp v65, v25, v65 row_ror:8 row_mask:0xf bank_mask:0xf
v_add_f32_dpp v66, v26, v66 row_ror:8 row_mask:0xf bank_mask:0xf
v_add_f32_dpp v67, v27, v67 row_ror:8 row_mask:0xf bank_mask:0xf
v_add_f32_dpp v68, v28, v68 row_ror:8 row_mask:0xf bank_mask:0xf
v_add_f32_dpp v69, v29, v69 row_ror:8 row_mask:0xf bank_mask:0xf
v_add_f32_dpp v70, v30, v70 row_ror:8 row_mask:0xf bank_mask:0xf
v_add_f32_dpp v71, v31, v71 row_ror:8 row_mask:0xf bank_mask:0xf
v_cvt_pk_bf16_f32 v40, v64, v65
v_lshlrev_b32 v64, 16, v40
v_and_b32 v65, s72, v40
v_pk_mul_f32 v[64:65], v[64:65], s[10:11]
v_cvt_pk_bf16_f32 v40, v64, v65
v_lshlrev_b32 v64, 16, v40
v_and_b32 v65, s72, v40
v_cvt_pk_bf16_f32 v41, v66, v67
v_lshlrev_b32 v66, 16, v41
v_and_b32 v67, s72, v41
v_pk_mul_f32 v[66:67], v[66:67], s[10:11]
v_cvt_pk_bf16_f32 v41, v66, v67
v_lshlrev_b32 v66, 16, v41
v_and_b32 v67, s72, v41
v_cvt_pk_bf16_f32 v40, v68, v69
v_lshlrev_b32 v68, 16, v40
v_and_b32 v69, s72, v40
v_pk_mul_f32 v[68:69], v[68:69], s[10:11]
v_cvt_pk_bf16_f32 v40, v68, v69
v_lshlrev_b32 v68, 16, v40
v_and_b32 v69, s72, v40
v_cvt_pk_bf16_f32 v41, v70, v71
v_lshlrev_b32 v70, 16, v41
v_and_b32 v71, s72, v41
v_pk_mul_f32 v[70:71], v[70:71], s[10:11]
v_cvt_pk_bf16_f32 v41, v70, v71
v_lshlrev_b32 v70, 16, v41
v_and_b32 v71, s72, v41
v_mfma_f32_16x16x32_bf16 v[80:83], a[64:67], v[16:19], 0
v_mfma_f32_16x16x32_bf16 v[24:27], a[72:75], v[16:19], 0
v_mfma_f32_16x16x32_bf16 v[84:87], a[80:83], v[16:19], 0
v_mfma_f32_16x16x32_bf16 v[28:31], a[88:91], v[16:19], 0
v_mfma_f32_16x16x32_bf16 v[80:83], a[68:71], v[20:23], v[80:83]
v_mfma_f32_16x16x32_bf16 v[24:27], a[76:79], v[20:23], v[24:27]
v_mfma_f32_16x16x32_bf16 v[84:87], a[84:87], v[20:23], v[84:87]
v_mfma_f32_16x16x32_bf16 v[28:31], a[92:95], v[20:23], v[28:31]
v_permlane32_swap_b32 v72, v32
v_permlane32_swap_b32 v73, v33
v_permlane32_swap_b32 v74, v34
v_permlane32_swap_b32 v75, v35
v_permlane32_swap_b32 v76, v36
v_permlane32_swap_b32 v77, v37
v_permlane32_swap_b32 v78, v38
v_permlane32_swap_b32 v79, v39
v_add_f32_dpp v72, v32, v72 row_ror:8 row_mask:0xf bank_mask:0xf
v_add_f32_dpp v73, v33, v73 row_ror:8 row_mask:0xf bank_mask:0xf
v_add_f32_dpp v74, v34, v74 row_ror:8 row_mask:0xf bank_mask:0xf
v_add_f32_dpp v75, v35, v75 row_ror:8 row_mask:0xf bank_mask:0xf
v_add_f32_dpp v76, v36, v76 row_ror:8 row_mask:0xf bank_mask:0xf
v_add_f32_dpp v77, v37, v77 row_ror:8 row_mask:0xf bank_mask:0xf
v_add_f32_dpp v78, v38, v78 row_ror:8 row_mask:0xf bank_mask:0xf
v_add_f32_dpp v79, v39, v79 row_ror:8 row_mask:0xf bank_mask:0xf
v_cvt_pk_bf16_f32 v40, v72, v73
v_lshlrev_b32 v72, 16, v40
v_and_b32 v73, s72, v40
v_pk_mul_f32 v[72:73], v[72:73], s[10:11]
v_cvt_pk_bf16_f32 v40, v72, v73
v_lshlrev_b32 v72, 16, v40
v_and_b32 v73, s72, v40
v_cvt_pk_bf16_f32 v41, v74, v75
v_lshlrev_b32 v74, 16, v41
v_and_b32 v75, s72, v41
v_pk_mul_f32 v[74:75], v[74:75], s[10:11]
v_cvt_pk_bf16_f32 v41, v74, v75
v_lshlrev_b32 v74, 16, v41
v_and_b32 v75, s72, v41
v_cvt_pk_bf16_f32 v40, v76, v77
v_lshlrev_b32 v76, 16, v40
v_and_b32 v77, s72, v40
v_pk_mul_f32 v[76:77], v[76:77], s[10:11]
v_cvt_pk_bf16_f32 v40, v76, v77
v_lshlrev_b32 v76, 16, v40
v_and_b32 v77, s72, v40
v_cvt_pk_bf16_f32 v41, v78, v79
v_lshlrev_b32 v78, 16, v41
v_and_b32 v79, s72, v41
v_pk_mul_f32 v[78:79], v[78:79], s[10:11]
v_cvt_pk_bf16_f32 v41, v78, v79
v_lshlrev_b32 v78, 16, v41
v_and_b32 v79, s72, v41
v_mfma_f32_16x16x32_bf16 v[88:91], a[96:99], v[16:19], 0
v_mfma_f32_16x16x32_bf16 v[32:35], a[104:107], v[16:19], 0
v_mfma_f32_16x16x32_bf16 v[92:95], a[112:115], v[16:19], 0
v_mfma_f32_16x16x32_bf16 v[36:39], a[120:123], v[16:19], 0
v_mfma_f32_16x16x32_bf16 v[88:91], a[100:103], v[20:23], v[88:91]
v_mfma_f32_16x16x32_bf16 v[32:35], a[108:111], v[20:23], v[32:35]
v_mfma_f32_16x16x32_bf16 v[92:95], a[116:119], v[20:23], v[92:95]
v_mfma_f32_16x16x32_bf16 v[36:39], a[124:127], v[20:23], v[36:39]
v_permlane32_swap_b32 v80, v24
v_permlane32_swap_b32 v81, v25
v_permlane32_swap_b32 v82, v26
v_permlane32_swap_b32 v83, v27
v_permlane32_swap_b32 v84, v28
v_permlane32_swap_b32 v85, v29
v_permlane32_swap_b32 v86, v30
v_permlane32_swap_b32 v87, v31
v_add_f32_dpp v80, v24, v80 row_ror:8 row_mask:0xf bank_mask:0xf
v_add_f32_dpp v81, v25, v81 row_ror:8 row_mask:0xf bank_mask:0xf
v_add_f32_dpp v82, v26, v82 row_ror:8 row_mask:0xf bank_mask:0xf
v_add_f32_dpp v83, v27, v83 row_ror:8 row_mask:0xf bank_mask:0xf
v_add_f32_dpp v84, v28, v84 row_ror:8 row_mask:0xf bank_mask:0xf
v_add_f32_dpp v85, v29, v85 row_ror:8 row_mask:0xf bank_mask:0xf
v_add_f32_dpp v86, v30, v86 row_ror:8 row_mask:0xf bank_mask:0xf
v_add_f32_dpp v87, v31, v87 row_ror:8 row_mask:0xf bank_mask:0xf
v_cvt_pk_bf16_f32 v40, v80, v81
v_lshlrev_b32 v80, 16, v40
v_and_b32 v81, s72, v40
v_pk_mul_f32 v[80:81], v[80:81], s[10:11]
v_cvt_pk_bf16_f32 v40, v80, v81
v_lshlrev_b32 v80, 16, v40
v_and_b32 v81, s72, v40
v_cvt_pk_bf16_f32 v41, v82, v83
v_lshlrev_b32 v82, 16, v41
v_and_b32 v83, s72, v41
v_pk_mul_f32 v[82:83], v[82:83], s[10:11]
v_cvt_pk_bf16_f32 v41, v82, v83
v_lshlrev_b32 v82, 16, v41
v_and_b32 v83, s72, v41
v_cvt_pk_bf16_f32 v40, v84, v85
v_lshlrev_b32 v84, 16, v40
v_and_b32 v85, s72, v40
v_pk_mul_f32 v[84:85], v[84:85], s[10:11]
v_cvt_pk_bf16_f32 v40, v84, v85
v_lshlrev_b32 v84, 16, v40
v_and_b32 v85, s72, v40
v_cvt_pk_bf16_f32 v41, v86, v87
v_lshlrev_b32 v86, 16, v41
v_and_b32 v87, s72, v41
v_pk_mul_f32 v[86:87], v[86:87], s[10:11]
v_cvt_pk_bf16_f32 v41, v86, v87
v_lshlrev_b32 v86, 16, v41
v_and_b32 v87, s72, v41
s_mov_b32 s74, 16384
buffer_load_dwordx4 v[192:195], v8, s[48:51], s74 offen offset:0 nt
buffer_load_dwordx4 v[196:199], v8, s[48:51], s74 offen offset:1024 nt
buffer_load_dwordx4 v[200:203], v8, s[48:51], s74 offen offset:2048 nt
buffer_load_dwordx4 v[204:207], v8, s[48:51], s74 offen offset:3072 nt
buffer_load_dwordx4 v[208:211], v9, s[48:51], s74 offen offset:0 nt
buffer_load_dwordx4 v[212:215], v9, s[48:51], s74 offen offset:1024 nt
buffer_load_dwordx4 v[216:219], v9, s[48:51], s74 offen offset:2048 nt
buffer_load_dwordx4 v[220:223], v9, s[48:51], s74 offen offset:3072 nt
v_mfma_f32_16x16x32_bf16 v[96:99], a[128:131], v[16:19], 0
v_mfma_f32_16x16x32_bf16 v[24:27], a[136:139], v[16:19], 0
v_mfma_f32_16x16x32_bf16 v[100:103], a[144:147], v[16:19], 0
v_mfma_f32_16x16x32_bf16 v[28:31], a[152:155], v[16:19], 0
v_mfma_f32_16x16x32_bf16 v[96:99], a[132:135], v[20:23], v[96:99]
v_mfma_f32_16x16x32_bf16 v[24:27], a[140:143], v[20:23], v[24:27]
v_mfma_f32_16x16x32_bf16 v[100:103], a[148:151], v[20:23], v[100:103]
v_mfma_f32_16x16x32_bf16 v[28:31], a[156:159], v[20:23], v[28:31]
v_permlane32_swap_b32 v88, v32
v_permlane32_swap_b32 v89, v33
v_permlane32_swap_b32 v90, v34
v_permlane32_swap_b32 v91, v35
v_permlane32_swap_b32 v92, v36
v_permlane32_swap_b32 v93, v37
v_permlane32_swap_b32 v94, v38
v_permlane32_swap_b32 v95, v39
v_add_f32_dpp v88, v32, v88 row_ror:8 row_mask:0xf bank_mask:0xf
v_add_f32_dpp v89, v33, v89 row_ror:8 row_mask:0xf bank_mask:0xf
v_add_f32_dpp v90, v34, v90 row_ror:8 row_mask:0xf bank_mask:0xf
v_add_f32_dpp v91, v35, v91 row_ror:8 row_mask:0xf bank_mask:0xf
v_add_f32_dpp v92, v36, v92 row_ror:8 row_mask:0xf bank_mask:0xf
v_add_f32_dpp v93, v37, v93 row_ror:8 row_mask:0xf bank_mask:0xf
v_add_f32_dpp v94, v38, v94 row_ror:8 row_mask:0xf bank_mask:0xf
v_add_f32_dpp v95, v39, v95 row_ror:8 row_mask:0xf bank_mask:0xf
v_cvt_pk_bf16_f32 v40, v88, v89
v_lshlrev_b32 v88, 16, v40
v_and_b32 v89, s72, v40
v_pk_mul_f32 v[88:89], v[88:89], s[10:11]
v_cvt_pk_bf16_f32 v40, v88, v89
v_lshlrev_b32 v88, 16, v40
v_and_b32 v89, s72, v40
v_cvt_pk_bf16_f32 v41, v90, v91
v_lshlrev_b32 v90, 16, v41
v_and_b32 v91, s72, v41
v_pk_mul_f32 v[90:91], v[90:91], s[10:11]
v_cvt_pk_bf16_f32 v41, v90, v91
v_lshlrev_b32 v90, 16, v41
v_and_b32 v91, s72, v41
v_cvt_pk_bf16_f32 v40, v92, v93
v_lshlrev_b32 v92, 16, v40
v_and_b32 v93, s72, v40
v_pk_mul_f32 v[92:93], v[92:93], s[10:11]
v_cvt_pk_bf16_f32 v40, v92, v93
v_lshlrev_b32 v92, 16, v40
v_and_b32 v93, s72, v40
v_cvt_pk_bf16_f32 v41, v94, v95
v_lshlrev_b32 v94, 16, v41
v_and_b32 v95, s72, v41
v_pk_mul_f32 v[94:95], v[94:95], s[10:11]
v_cvt_pk_bf16_f32 v41, v94, v95
v_lshlrev_b32 v94, 16, v41
v_and_b32 v95, s72, v41
v_mfma_f32_16x16x32_bf16 v[104:107], a[160:163], v[16:19], 0
v_mfma_f32_16x16x32_bf16 v[32:35], a[168:171], v[16:19], 0
v_mfma_f32_16x16x32_bf16 v[108:111], a[176:179], v[16:19], 0
v_mfma_f32_16x16x32_bf16 v[36:39], a[184:187], v[16:19], 0
v_mfma_f32_16x16x32_bf16 v[104:107], a[164:167], v[20:23], v[104:107]
v_mfma_f32_16x16x32_bf16 v[32:35], a[172:175], v[20:23], v[32:35]
v_mfma_f32_16x16x32_bf16 v[108:111], a[180:183], v[20:23], v[108:111]
v_mfma_f32_16x16x32_bf16 v[36:39], a[188:191], v[20:23], v[36:39]
v_permlane32_swap_b32 v96, v24
v_permlane32_swap_b32 v97, v25
v_permlane32_swap_b32 v98, v26
v_permlane32_swap_b32 v99, v27
v_permlane32_swap_b32 v100, v28
v_permlane32_swap_b32 v101, v29
v_permlane32_swap_b32 v102, v30
v_permlane32_swap_b32 v103, v31
v_add_f32_dpp v96, v24, v96 row_ror:8 row_mask:0xf bank_mask:0xf
v_add_f32_dpp v97, v25, v97 row_ror:8 row_mask:0xf bank_mask:0xf
v_add_f32_dpp v98, v26, v98 row_ror:8 row_mask:0xf bank_mask:0xf
v_add_f32_dpp v99, v27, v99 row_ror:8 row_mask:0xf bank_mask:0xf
v_add_f32_dpp v100, v28, v100 row_ror:8 row_mask:0xf bank_mask:0xf
v_add_f32_dpp v101, v29, v101 row_ror:8 row_mask:0xf bank_mask:0xf
v_add_f32_dpp v102, v30, v102 row_ror:8 row_mask:0xf bank_mask:0xf
v_add_f32_dpp v103, v31, v103 row_ror:8 row_mask:0xf bank_mask:0xf
v_cvt_pk_bf16_f32 v40, v96, v97
v_lshlrev_b32 v96, 16, v40
v_and_b32 v97, s72, v40
v_pk_mul_f32 v[96:97], v[96:97], s[10:11]
v_cvt_pk_bf16_f32 v40, v96, v97
v_lshlrev_b32 v96, 16, v40
v_and_b32 v97, s72, v40
v_cvt_pk_bf16_f32 v41, v98, v99
v_lshlrev_b32 v98, 16, v41
v_and_b32 v99, s72, v41
v_pk_mul_f32 v[98:99], v[98:99], s[10:11]
v_cvt_pk_bf16_f32 v41, v98, v99
v_lshlrev_b32 v98, 16, v41
v_and_b32 v99, s72, v41
v_cvt_pk_bf16_f32 v40, v100, v101
v_lshlrev_b32 v100, 16, v40
v_and_b32 v101, s72, v40
v_pk_mul_f32 v[100:101], v[100:101], s[10:11]
v_cvt_pk_bf16_f32 v40, v100, v101
v_lshlrev_b32 v100, 16, v40
v_and_b32 v101, s72, v40
v_cvt_pk_bf16_f32 v41, v102, v103
v_lshlrev_b32 v102, 16, v41
v_and_b32 v103, s72, v41
v_pk_mul_f32 v[102:103], v[102:103], s[10:11]
v_cvt_pk_bf16_f32 v41, v102, v103
v_lshlrev_b32 v102, 16, v41
v_and_b32 v103, s72, v41
v_mfma_f32_16x16x32_bf16 v[112:115], a[192:195], v[16:19], 0
v_mfma_f32_16x16x32_bf16 v[24:27], a[200:203], v[16:19], 0
v_mfma_f32_16x16x32_bf16 v[116:119], a[208:211], v[16:19], 0
v_mfma_f32_16x16x32_bf16 v[28:31], a[216:219], v[16:19], 0
v_mfma_f32_16x16x32_bf16 v[112:115], a[196:199], v[20:23], v[112:115]
v_mfma_f32_16x16x32_bf16 v[24:27], a[204:207], v[20:23], v[24:27]
v_mfma_f32_16x16x32_bf16 v[116:119], a[212:215], v[20:23], v[116:119]
v_mfma_f32_16x16x32_bf16 v[28:31], a[220:223], v[20:23], v[28:31]
v_permlane32_swap_b32 v104, v32
v_permlane32_swap_b32 v105, v33
v_permlane32_swap_b32 v106, v34
v_permlane32_swap_b32 v107, v35
v_permlane32_swap_b32 v108, v36
v_permlane32_swap_b32 v109, v37
v_permlane32_swap_b32 v110, v38
v_permlane32_swap_b32 v111, v39
v_add_f32_dpp v104, v32, v104 row_ror:8 row_mask:0xf bank_mask:0xf
v_add_f32_dpp v105, v33, v105 row_ror:8 row_mask:0xf bank_mask:0xf
v_add_f32_dpp v106, v34, v106 row_ror:8 row_mask:0xf bank_mask:0xf
v_add_f32_dpp v107, v35, v107 row_ror:8 row_mask:0xf bank_mask:0xf
v_add_f32_dpp v108, v36, v108 row_ror:8 row_mask:0xf bank_mask:0xf
v_add_f32_dpp v109, v37, v109 row_ror:8 row_mask:0xf bank_mask:0xf
v_add_f32_dpp v110, v38, v110 row_ror:8 row_mask:0xf bank_mask:0xf
v_add_f32_dpp v111, v39, v111 row_ror:8 row_mask:0xf bank_mask:0xf
v_cvt_pk_bf16_f32 v40, v104, v105
v_lshlrev_b32 v104, 16, v40
v_and_b32 v105, s72, v40
v_pk_mul_f32 v[104:105], v[104:105], s[10:11]
v_cvt_pk_bf16_f32 v40, v104, v105
v_lshlrev_b32 v104, 16, v40
v_and_b32 v105, s72, v40
v_cvt_pk_bf16_f32 v41, v106, v107
v_lshlrev_b32 v106, 16, v41
v_and_b32 v107, s72, v41
v_pk_mul_f32 v[106:107], v[106:107], s[10:11]
v_cvt_pk_bf16_f32 v41, v106, v107
v_lshlrev_b32 v106, 16, v41
v_and_b32 v107, s72, v41
v_cvt_pk_bf16_f32 v40, v108, v109
v_lshlrev_b32 v108, 16, v40
v_and_b32 v109, s72, v40
v_pk_mul_f32 v[108:109], v[108:109], s[10:11]
v_cvt_pk_bf16_f32 v40, v108, v109
v_lshlrev_b32 v108, 16, v40
v_and_b32 v109, s72, v40
v_cvt_pk_bf16_f32 v41, v110, v111
v_lshlrev_b32 v110, 16, v41
v_and_b32 v111, s72, v41
v_pk_mul_f32 v[110:111], v[110:111], s[10:11]
v_cvt_pk_bf16_f32 v41, v110, v111
v_lshlrev_b32 v110, 16, v41
v_and_b32 v111, s72, v41
v_mfma_f32_16x16x32_bf16 v[120:123], a[224:227], v[16:19], 0
v_mfma_f32_16x16x32_bf16 v[32:35], a[232:235], v[16:19], 0
v_mfma_f32_16x16x32_bf16 v[124:127], a[240:243], v[16:19], 0
v_mfma_f32_16x16x32_bf16 v[36:39], a[248:251], v[16:19], 0
v_mfma_f32_16x16x32_bf16 v[120:123], a[228:231], v[20:23], v[120:123]
v_mfma_f32_16x16x32_bf16 v[32:35], a[236:239], v[20:23], v[32:35]
v_mfma_f32_16x16x32_bf16 v[124:127], a[244:247], v[20:23], v[124:127]
v_mfma_f32_16x16x32_bf16 v[36:39], a[252:255], v[20:23], v[36:39]
v_permlane32_swap_b32 v112, v24
v_permlane32_swap_b32 v113, v25
v_permlane32_swap_b32 v114, v26
v_permlane32_swap_b32 v115, v27
v_permlane32_swap_b32 v116, v28
v_permlane32_swap_b32 v117, v29
v_permlane32_swap_b32 v118, v30
v_permlane32_swap_b32 v119, v31
v_add_f32_dpp v112, v24, v112 row_ror:8 row_mask:0xf bank_mask:0xf
v_add_f32_dpp v113, v25, v113 row_ror:8 row_mask:0xf bank_mask:0xf
v_add_f32_dpp v114, v26, v114 row_ror:8 row_mask:0xf bank_mask:0xf
v_add_f32_dpp v115, v27, v115 row_ror:8 row_mask:0xf bank_mask:0xf
v_add_f32_dpp v116, v28, v116 row_ror:8 row_mask:0xf bank_mask:0xf
v_add_f32_dpp v117, v29, v117 row_ror:8 row_mask:0xf bank_mask:0xf
v_add_f32_dpp v118, v30, v118 row_ror:8 row_mask:0xf bank_mask:0xf
v_add_f32_dpp v119, v31, v119 row_ror:8 row_mask:0xf bank_mask:0xf
v_cvt_pk_bf16_f32 v40, v112, v113
v_lshlrev_b32 v112, 16, v40
v_and_b32 v113, s72, v40
v_pk_mul_f32 v[112:113], v[112:113], s[10:11]
v_cvt_pk_bf16_f32 v40, v112, v113
v_lshlrev_b32 v112, 16, v40
v_and_b32 v113, s72, v40
v_cvt_pk_bf16_f32 v41, v114, v115
v_lshlrev_b32 v114, 16, v41
v_and_b32 v115, s72, v41
v_pk_mul_f32 v[114:115], v[114:115], s[10:11]
v_cvt_pk_bf16_f32 v41, v114, v115
v_lshlrev_b32 v114, 16, v41
v_and_b32 v115, s72, v41
v_cvt_pk_bf16_f32 v40, v116, v117
v_lshlrev_b32 v116, 16, v40
v_and_b32 v117, s72, v40
v_pk_mul_f32 v[116:117], v[116:117], s[10:11]
v_cvt_pk_bf16_f32 v40, v116, v117
v_lshlrev_b32 v116, 16, v40
v_and_b32 v117, s72, v40
v_cvt_pk_bf16_f32 v41, v118, v119
v_lshlrev_b32 v118, 16, v41
v_and_b32 v119, s72, v41
v_pk_mul_f32 v[118:119], v[118:119], s[10:11]
v_cvt_pk_bf16_f32 v41, v118, v119
v_lshlrev_b32 v118, 16, v41
v_and_b32 v119, s72, v41
s_mov_b32 s74, 24576
buffer_load_dwordx4 v[224:227], v8, s[48:51], s74 offen offset:0 nt
buffer_load_dwordx4 v[228:231], v8, s[48:51], s74 offen offset:1024 nt
buffer_load_dwordx4 v[232:235], v8, s[48:51], s74 offen offset:2048 nt
buffer_load_dwordx4 v[236:239], v8, s[48:51], s74 offen offset:3072 nt
buffer_load_dwordx4 v[240:243], v9, s[48:51], s74 offen offset:0 nt
buffer_load_dwordx4 v[244:247], v9, s[48:51], s74 offen offset:1024 nt
buffer_load_dwordx4 v[248:251], v9, s[48:51], s74 offen offset:2048 nt
buffer_load_dwordx4 v[252:255], v9, s[48:51], s74 offen offset:3072 nt
v_permlane32_swap_b32 v120, v32
v_permlane32_swap_b32 v121, v33
v_permlane32_swap_b32 v122, v34
v_permlane32_swap_b32 v123, v35
v_permlane32_swap_b32 v124, v36
v_permlane32_swap_b32 v125, v37
v_permlane32_swap_b32 v126, v38
v_permlane32_swap_b32 v127, v39
v_add_f32_dpp v120, v32, v120 row_ror:8 row_mask:0xf bank_mask:0xf
v_add_f32_dpp v121, v33, v121 row_ror:8 row_mask:0xf bank_mask:0xf
v_add_f32_dpp v122, v34, v122 row_ror:8 row_mask:0xf bank_mask:0xf
v_add_f32_dpp v123, v35, v123 row_ror:8 row_mask:0xf bank_mask:0xf
v_add_f32_dpp v124, v36, v124 row_ror:8 row_mask:0xf bank_mask:0xf
v_add_f32_dpp v125, v37, v125 row_ror:8 row_mask:0xf bank_mask:0xf
v_add_f32_dpp v126, v38, v126 row_ror:8 row_mask:0xf bank_mask:0xf
v_add_f32_dpp v127, v39, v127 row_ror:8 row_mask:0xf bank_mask:0xf
v_cvt_pk_bf16_f32 v40, v120, v121
v_lshlrev_b32 v120, 16, v40
v_and_b32 v121, s72, v40
v_pk_mul_f32 v[120:121], v[120:121], s[10:11]
v_cvt_pk_bf16_f32 v40, v120, v121
v_lshlrev_b32 v120, 16, v40
v_and_b32 v121, s72, v40
v_cvt_pk_bf16_f32 v41, v122, v123
v_lshlrev_b32 v122, 16, v41
v_and_b32 v123, s72, v41
v_pk_mul_f32 v[122:123], v[122:123], s[10:11]
v_cvt_pk_bf16_f32 v41, v122, v123
v_lshlrev_b32 v122, 16, v41
v_and_b32 v123, s72, v41
v_cvt_pk_bf16_f32 v40, v124, v125
v_lshlrev_b32 v124, 16, v40
v_and_b32 v125, s72, v40
v_pk_mul_f32 v[124:125], v[124:125], s[10:11]
v_cvt_pk_bf16_f32 v40, v124, v125
v_lshlrev_b32 v124, 16, v40
v_and_b32 v125, s72, v40
v_cvt_pk_bf16_f32 v41, v126, v127
v_lshlrev_b32 v126, 16, v41
v_and_b32 v127, s72, v41
v_pk_mul_f32 v[126:127], v[126:127], s[10:11]
v_cvt_pk_bf16_f32 v41, v126, v127
v_lshlrev_b32 v126, 16, v41
v_and_b32 v127, s72, v41
v_max3_f32 v40, v64, v65, v66
v_max3_f32 v41, v67, v68, v69
v_max3_f32 v40, v40, v70, v71
v_max3_f32 v41, v41, v72, v73
v_max3_f32 v40, v40, v74, v75
v_max3_f32 v41, v41, v76, v77
v_max3_f32 v40, v40, v78, v79
v_max3_f32 v41, v41, v80, v81
v_max3_f32 v40, v40, v82, v83
v_max3_f32 v41, v41, v84, v85
v_max3_f32 v40, v40, v86, v87
v_max3_f32 v41, v41, v88, v89
v_max3_f32 v40, v40, v90, v91
v_max3_f32 v41, v41, v92, v93
v_max3_f32 v40, v40, v94, v95
v_max3_f32 v41, v41, v96, v97
v_max3_f32 v40, v40, v98, v99
v_max3_f32 v41, v41, v100, v101
v_max3_f32 v40, v40, v102, v103
v_max3_f32 v41, v41, v104, v105
v_max3_f32 v40, v40, v106, v107
v_max3_f32 v41, v41, v108, v109
v_max3_f32 v40, v40, v110, v111
v_max3_f32 v41, v41, v112, v113
v_max3_f32 v40, v40, v114, v115
v_max3_f32 v41, v41, v116, v117
v_max3_f32 v40, v40, v118, v119
v_max3_f32 v41, v41, v120, v121
v_max3_f32 v40, v40, v122, v123
v_max3_f32 v41, v41, v124, v125
v_max3_f32 v40, v40, v126, v127
v_max_f32 v40, v40, v41
v_mov_b32 v41, v40
    s_nop 1
v_permlane16_swap_b32 v40, v41
v_max_f32 v40, v40, v41
v_mov_b32 v41, v40
    s_nop 1
v_permlane32_swap_b32 v40, v41
v_max_f32 v40, v40, v41

    v_and_b32 v42, 15, v1
    v_lshlrev_b32 v42, 2, v42
    v_lshlrev_b32 v43, 6, v10
    v_add_u32 v43, v43, v42
    ds_write_b32 v43, v40 offset:1664
    s_waitcnt lgkmcnt(0)
    s_barrier
    ds_read_b32 v44, v42 offset:1664
    ds_read_b32 v45, v42 offset:1728
    ds_read_b32 v46, v42 offset:1792
    ds_read_b32 v47, v42 offset:1856
    s_mov_b32 s10, 0x3fb8aa3b
    s_waitcnt lgkmcnt(0)
    v_max3_f32 v44, v44, v45, v46
    v_max_f32 v44, v44, v47
    v_mul_f32 v45, s10, v44

v_fma_f32 v64, v64, s10, -v45
v_fma_f32 v65, v65, s10, -v45
v_fma_f32 v66, v66, s10, -v45
v_fma_f32 v67, v67, s10, -v45
v_fma_f32 v68, v68, s10, -v45
v_fma_f32 v69, v69, s10, -v45
v_fma_f32 v70, v70, s10, -v45
v_fma_f32 v71, v71, s10, -v45
v_fma_f32 v72, v72, s10, -v45
v_fma_f32 v73, v73, s10, -v45
v_fma_f32 v74, v74, s10, -v45
v_fma_f32 v75, v75, s10, -v45
v_fma_f32 v76, v76, s10, -v45
v_fma_f32 v77, v77, s10, -v45
v_fma_f32 v78, v78, s10, -v45
v_fma_f32 v79, v79, s10, -v45
v_fma_f32 v80, v80, s10, -v45
v_fma_f32 v81, v81, s10, -v45
v_fma_f32 v82, v82, s10, -v45
v_fma_f32 v83, v83, s10, -v45
v_fma_f32 v84, v84, s10, -v45
v_fma_f32 v85, v85, s10, -v45
v_fma_f32 v86, v86, s10, -v45
v_fma_f32 v87, v87, s10, -v45
v_fma_f32 v88, v88, s10, -v45
v_fma_f32 v89, v89, s10, -v45
v_fma_f32 v90, v90, s10, -v45
v_fma_f32 v91, v91, s10, -v45
v_fma_f32 v92, v92, s10, -v45
v_fma_f32 v93, v93, s10, -v45
v_fma_f32 v94, v94, s10, -v45
v_fma_f32 v95, v95, s10, -v45
v_fma_f32 v96, v96, s10, -v45
v_fma_f32 v97, v97, s10, -v45
v_fma_f32 v98, v98, s10, -v45
v_fma_f32 v99, v99, s10, -v45
v_fma_f32 v100, v100, s10, -v45
v_fma_f32 v101, v101, s10, -v45
v_fma_f32 v102, v102, s10, -v45
v_fma_f32 v103, v103, s10, -v45
v_fma_f32 v104, v104, s10, -v45
v_fma_f32 v105, v105, s10, -v45
v_fma_f32 v106, v106, s10, -v45
v_fma_f32 v107, v107, s10, -v45
v_fma_f32 v108, v108, s10, -v45
v_fma_f32 v109, v109, s10, -v45
v_fma_f32 v110, v110, s10, -v45
v_fma_f32 v111, v111, s10, -v45
v_fma_f32 v112, v112, s10, -v45
v_fma_f32 v113, v113, s10, -v45
v_fma_f32 v114, v114, s10, -v45
v_fma_f32 v115, v115, s10, -v45
v_fma_f32 v116, v116, s10, -v45
v_fma_f32 v117, v117, s10, -v45
v_fma_f32 v118, v118, s10, -v45
v_fma_f32 v119, v119, s10, -v45
v_fma_f32 v120, v120, s10, -v45
v_fma_f32 v121, v121, s10, -v45
v_fma_f32 v122, v122, s10, -v45
v_fma_f32 v123, v123, s10, -v45
v_fma_f32 v124, v124, s10, -v45
v_fma_f32 v125, v125, s10, -v45
v_fma_f32 v126, v126, s10, -v45
v_fma_f32 v127, v127, s10, -v45
v_exp_f32 v64, v64
v_exp_f32 v65, v65
v_exp_f32 v66, v66
v_exp_f32 v67, v67
v_exp_f32 v68, v68
v_exp_f32 v69, v69
v_exp_f32 v70, v70
v_exp_f32 v71, v71
v_exp_f32 v72, v72
v_exp_f32 v73, v73
v_exp_f32 v74, v74
v_exp_f32 v75, v75
v_exp_f32 v76, v76
v_exp_f32 v77, v77
v_exp_f32 v78, v78
v_exp_f32 v79, v79
v_exp_f32 v80, v80
v_exp_f32 v81, v81
v_exp_f32 v82, v82
v_exp_f32 v83, v83
v_exp_f32 v84, v84
v_exp_f32 v85, v85
v_exp_f32 v86, v86
v_exp_f32 v87, v87
v_exp_f32 v88, v88
v_exp_f32 v89, v89
v_exp_f32 v90, v90
v_exp_f32 v91, v91
v_exp_f32 v92, v92
v_exp_f32 v93, v93
v_exp_f32 v94, v94
v_exp_f32 v95, v95
v_exp_f32 v96, v96
v_exp_f32 v97, v97
v_exp_f32 v98, v98
v_exp_f32 v99, v99
v_exp_f32 v100, v100
v_exp_f32 v101, v101
v_exp_f32 v102, v102
v_exp_f32 v103, v103
v_exp_f32 v104, v104
v_exp_f32 v105, v105
v_exp_f32 v106, v106
v_exp_f32 v107, v107
v_exp_f32 v108, v108
v_exp_f32 v109, v109
v_exp_f32 v110, v110
v_exp_f32 v111, v111
v_exp_f32 v112, v112
v_exp_f32 v113, v113
v_exp_f32 v114, v114
v_exp_f32 v115, v115
v_exp_f32 v116, v116
v_exp_f32 v117, v117
v_exp_f32 v118, v118
v_exp_f32 v119, v119
v_exp_f32 v120, v120
v_exp_f32 v121, v121
v_exp_f32 v122, v122
v_exp_f32 v123, v123
v_exp_f32 v124, v124
v_exp_f32 v125, v125
v_exp_f32 v126, v126
v_exp_f32 v127, v127
v_add_f32 v46, v64, v65
v_add_f32 v47, v66, v67
v_add_f32 v46, v46, v68
v_add_f32 v47, v47, v69
v_add_f32 v46, v46, v70
v_add_f32 v47, v47, v71
v_add_f32 v46, v46, v72
v_add_f32 v47, v47, v73
v_add_f32 v46, v46, v74
v_add_f32 v47, v47, v75
v_add_f32 v46, v46, v76
v_add_f32 v47, v47, v77
v_add_f32 v46, v46, v78
v_add_f32 v47, v47, v79
v_add_f32 v46, v46, v80
v_add_f32 v47, v47, v81
v_add_f32 v46, v46, v82
v_add_f32 v47, v47, v83
v_add_f32 v46, v46, v84
v_add_f32 v47, v47, v85
v_add_f32 v46, v46, v86
v_add_f32 v47, v47, v87
v_add_f32 v46, v46, v88
v_add_f32 v47, v47, v89
v_add_f32 v46, v46, v90
v_add_f32 v47, v47, v91
v_add_f32 v46, v46, v92
v_add_f32 v47, v47, v93
v_add_f32 v46, v46, v94
v_add_f32 v47, v47, v95
v_add_f32 v46, v46, v96
v_add_f32 v47, v47, v97
v_add_f32 v46, v46, v98
v_add_f32 v47, v47, v99
v_add_f32 v46, v46, v100
v_add_f32 v47, v47, v101
v_add_f32 v46, v46, v102
v_add_f32 v47, v47, v103
v_add_f32 v46, v46, v104
v_add_f32 v47, v47, v105
v_add_f32 v46, v46, v106
v_add_f32 v47, v47, v107
v_add_f32 v46, v46, v108
v_add_f32 v47, v47, v109
v_add_f32 v46, v46, v110
v_add_f32 v47, v47, v111
v_add_f32 v46, v46, v112
v_add_f32 v47, v47, v113
v_add_f32 v46, v46, v114
v_add_f32 v47, v47, v115
v_add_f32 v46, v46, v116
v_add_f32 v47, v47, v117
v_add_f32 v46, v46, v118
v_add_f32 v47, v47, v119
v_add_f32 v46, v46, v120
v_add_f32 v47, v47, v121
v_add_f32 v46, v46, v122
v_add_f32 v47, v47, v123
v_add_f32 v46, v46, v124
v_add_f32 v47, v47, v125
v_add_f32 v46, v46, v126
v_add_f32 v47, v47, v127
v_add_f32 v46, v46, v47
v_cvt_pk_bf16_f32 v64, v64, v65
v_cvt_pk_bf16_f32 v65, v66, v67
v_cvt_pk_bf16_f32 v66, v68, v69
v_cvt_pk_bf16_f32 v67, v70, v71
v_cvt_pk_bf16_f32 v68, v72, v73
v_cvt_pk_bf16_f32 v69, v74, v75
v_cvt_pk_bf16_f32 v70, v76, v77
v_cvt_pk_bf16_f32 v71, v78, v79
v_cvt_pk_bf16_f32 v72, v80, v81
v_cvt_pk_bf16_f32 v73, v82, v83
v_cvt_pk_bf16_f32 v74, v84, v85
v_cvt_pk_bf16_f32 v75, v86, v87
v_cvt_pk_bf16_f32 v76, v88, v89
v_cvt_pk_bf16_f32 v77, v90, v91
v_cvt_pk_bf16_f32 v78, v92, v93
v_cvt_pk_bf16_f32 v79, v94, v95
v_cvt_pk_bf16_f32 v80, v96, v97
v_cvt_pk_bf16_f32 v81, v98, v99
v_cvt_pk_bf16_f32 v82, v100, v101
v_cvt_pk_bf16_f32 v83, v102, v103
v_cvt_pk_bf16_f32 v84, v104, v105
v_cvt_pk_bf16_f32 v85, v106, v107
v_cvt_pk_bf16_f32 v86, v108, v109
v_cvt_pk_bf16_f32 v87, v110, v111
v_cvt_pk_bf16_f32 v88, v112, v113
v_cvt_pk_bf16_f32 v89, v114, v115
v_cvt_pk_bf16_f32 v90, v116, v117
v_cvt_pk_bf16_f32 v91, v118, v119
v_cvt_pk_bf16_f32 v92, v120, v121
v_cvt_pk_bf16_f32 v93, v122, v123
v_cvt_pk_bf16_f32 v94, v124, v125
v_cvt_pk_bf16_f32 v95, v126, v127
v_mov_b32 v47, v46
    s_nop 1
v_permlane16_swap_b32 v46, v47
v_add_f32 v46, v46, v47
v_mov_b32 v47, v46
    s_nop 1
v_permlane32_swap_b32 v46, v47
v_add_f32 v46, v46, v47
ds_write_b32 v43, v46 offset:1920

    s_waitcnt lgkmcnt(0)
    s_barrier
    s_cmp_lg_u32 s3, 0
    s_cbranch_scc1 L_noml
    ds_read_b32 v46, v42 offset:1920
    ds_read_b32 v47, v42 offset:1984
    ds_read_b32 v48, v42 offset:2048
    ds_read_b32 v49, v42 offset:2112
    v_lshlrev_b32 v50, 7, v42
    s_lshl_b32 s73, s5, 12
    s_lshl_b32 s74, s4, 8
    s_add_u32 s73, s73, s74
    s_lshl_b32 s74, s6, 3
    s_add_u32 s73, s73, s74
    s_add_u32 s73, s73, 393216
    s_waitcnt lgkmcnt(0)
    v_add_f32 v46, v46, v47
    v_add_f32 v48, v48, v49
    v_add_f32 v45, v46, v48
    s_mov_b64 exec, 0xff

buffer_store_dwordx2 v[44:45], v50, s[60:63], s73 offen sc1
s_mov_b64 exec, -1
L_noml:
v_lshlrev_b32 v11, 3, v0
s_waitcnt vmcnt(24)
v_perm_b32 v16, v132, v128, s100
v_perm_b32 v17, v140, v136, s100
v_perm_b32 v18, v148, v144, s100
v_perm_b32 v19, v156, v152, s100
    s_nop 1
v_mfma_f32_16x16x32_bf16 v[32:35], v[16:19], v[64:67], 0
v_perm_b32 v20, v132, v128, s101
v_perm_b32 v21, v140, v136, s101
v_perm_b32 v22, v148, v144, s101
v_perm_b32 v23, v156, v152, s101
    s_nop 1
v_mfma_f32_16x16x32_bf16 v[36:39], v[20:23], v[64:67], 0
v_perm_b32 v24, v133, v129, s100
v_perm_b32 v25, v141, v137, s100
v_perm_b32 v26, v149, v145, s100
v_perm_b32 v27, v157, v153, s100
    s_nop 1
v_mfma_f32_16x16x32_bf16 v[40:43], v[24:27], v[64:67], 0
v_perm_b32 v28, v133, v129, s101
v_perm_b32 v29, v141, v137, s101
v_perm_b32 v30, v149, v145, s101
v_perm_b32 v31, v157, v153, s101
    s_nop 1
v_mfma_f32_16x16x32_bf16 v[44:47], v[28:31], v[64:67], 0
v_perm_b32 v16, v134, v130, s100
v_perm_b32 v17, v142, v138, s100
v_perm_b32 v18, v150, v146, s100
v_perm_b32 v19, v158, v154, s100
    s_nop 1
v_mfma_f32_16x16x32_bf16 v[48:51], v[16:19], v[64:67], 0
v_perm_b32 v20, v134, v130, s101
v_perm_b32 v21, v142, v138, s101
v_perm_b32 v22, v150, v146, s101
v_perm_b32 v23, v158, v154, s101
    s_nop 1
v_mfma_f32_16x16x32_bf16 v[52:55], v[20:23], v[64:67], 0
v_perm_b32 v24, v135, v131, s100
v_perm_b32 v25, v143, v139, s100
v_perm_b32 v26, v151, v147, s100
v_perm_b32 v27, v159, v155, s100
    s_nop 1
v_mfma_f32_16x16x32_bf16 v[56:59], v[24:27], v[64:67], 0
v_perm_b32 v28, v135, v131, s101
v_perm_b32 v29, v143, v139, s101
v_perm_b32 v30, v151, v147, s101
v_perm_b32 v31, v159, v155, s101
    s_nop 1
v_mfma_f32_16x16x32_bf16 v[60:63], v[28:31], v[64:67], 0
s_waitcnt vmcnt(24)
s_mov_b32 s74, 32768
buffer_load_dwordx4 v[128:131], v8, s[48:51], s74 offen offset:0 nt
buffer_load_dwordx4 v[132:135], v8, s[48:51], s74 offen offset:1024 nt
buffer_load_dwordx4 v[136:139], v8, s[48:51], s74 offen offset:2048 nt
buffer_load_dwordx4 v[140:143], v8, s[48:51], s74 offen offset:3072 nt
buffer_load_dwordx4 v[144:147], v9, s[48:51], s74 offen offset:0 nt
buffer_load_dwordx4 v[148:151], v9, s[48:51], s74 offen offset:1024 nt
buffer_load_dwordx4 v[152:155], v9, s[48:51], s74 offen offset:2048 nt
buffer_load_dwordx4 v[156:159], v9, s[48:51], s74 offen offset:3072 nt
s_waitcnt vmcnt(24)
v_perm_b32 v16, v164, v160, s100
v_perm_b32 v17, v172, v168, s100
v_perm_b32 v18, v180, v176, s100
v_perm_b32 v19, v188, v184, s100
    s_nop 1
v_mfma_f32_16x16x32_bf16 v[32:35], v[16:19], v[68:71], v[32:35]
v_perm_b32 v20, v164, v160, s101
v_perm_b32 v21, v172, v168, s101
v_perm_b32 v22, v180, v176, s101
v_perm_b32 v23, v188, v184, s101
    s_nop 1
v_mfma_f32_16x16x32_bf16 v[36:39], v[20:23], v[68:71], v[36:39]
v_perm_b32 v24, v165, v161, s100
v_perm_b32 v25, v173, v169, s100
v_perm_b32 v26, v181, v177, s100
v_perm_b32 v27, v189, v185, s100
    s_nop 1
v_mfma_f32_16x16x32_bf16 v[40:43], v[24:27], v[68:71], v[40:43]
v_perm_b32 v28, v165, v161, s101
v_perm_b32 v29, v173, v169, s101
v_perm_b32 v30, v181, v177, s101
v_perm_b32 v31, v189, v185, s101
    s_nop 1
v_mfma_f32_16x16x32_bf16 v[44:47], v[28:31], v[68:71], v[44:47]
v_perm_b32 v16, v166, v162, s100
v_perm_b32 v17, v174, v170, s100
v_perm_b32 v18, v182, v178, s100
v_perm_b32 v19, v190, v186, s100
    s_nop 1
v_mfma_f32_16x16x32_bf16 v[48:51], v[16:19], v[68:71], v[48:51]
v_perm_b32 v20, v166, v162, s101
v_perm_b32 v21, v174, v170, s101
v_perm_b32 v22, v182, v178, s101
v_perm_b32 v23, v190, v186, s101
    s_nop 1
v_mfma_f32_16x16x32_bf16 v[52:55], v[20:23], v[68:71], v[52:55]
v_perm_b32 v24, v167, v163, s100
v_perm_b32 v25, v175, v171, s100
v_perm_b32 v26, v183, v179, s100
v_perm_b32 v27, v191, v187, s100
    s_nop 1
v_mfma_f32_16x16x32_bf16 v[56:59], v[24:27], v[68:71], v[56:59]
v_perm_b32 v28, v167, v163, s101
v_perm_b32 v29, v175, v171, s101
v_perm_b32 v30, v183, v179, s101
v_perm_b32 v31, v191, v187, s101
    s_nop 1
v_mfma_f32_16x16x32_bf16 v[60:63], v[28:31], v[68:71], v[60:63]
s_waitcnt vmcnt(24)
s_mov_b32 s74, 40960
buffer_load_dwordx4 v[160:163], v8, s[48:51], s74 offen offset:0 nt
buffer_load_dwordx4 v[164:167], v8, s[48:51], s74 offen offset:1024 nt
buffer_load_dwordx4 v[168:171], v8, s[48:51], s74 offen offset:2048 nt
buffer_load_dwordx4 v[172:175], v8, s[48:51], s74 offen offset:3072 nt
buffer_load_dwordx4 v[176:179], v9, s[48:51], s74 offen offset:0 nt
buffer_load_dwordx4 v[180:183], v9, s[48:51], s74 offen offset:1024 nt
buffer_load_dwordx4 v[184:187], v9, s[48:51], s74 offen offset:2048 nt
buffer_load_dwordx4 v[188:191], v9, s[48:51], s74 offen offset:3072 nt
s_waitcnt vmcnt(24)
v_perm_b32 v16, v196, v192, s100
v_perm_b32 v17, v204, v200, s100
v_perm_b32 v18, v212, v208, s100
v_perm_b32 v19, v220, v216, s100
    s_nop 1
v_mfma_f32_16x16x32_bf16 v[32:35], v[16:19], v[72:75], v[32:35]
v_perm_b32 v20, v196, v192, s101
v_perm_b32 v21, v204, v200, s101
v_perm_b32 v22, v212, v208, s101
v_perm_b32 v23, v220, v216, s101
    s_nop 1
v_mfma_f32_16x16x32_bf16 v[36:39], v[20:23], v[72:75], v[36:39]
v_perm_b32 v24, v197, v193, s100
v_perm_b32 v25, v205, v201, s100
v_perm_b32 v26, v213, v209, s100
v_perm_b32 v27, v221, v217, s100
    s_nop 1
v_mfma_f32_16x16x32_bf16 v[40:43], v[24:27], v[72:75], v[40:43]
v_perm_b32 v28, v197, v193, s101
v_perm_b32 v29, v205, v201, s101
v_perm_b32 v30, v213, v209, s101
v_perm_b32 v31, v221, v217, s101
    s_nop 1
v_mfma_f32_16x16x32_bf16 v[44:47], v[28:31], v[72:75], v[44:47]
v_perm_b32 v16, v198, v194, s100
v_perm_b32 v17, v206, v202, s100
v_perm_b32 v18, v214, v210, s100
v_perm_b32 v19, v222, v218, s100
    s_nop 1
v_mfma_f32_16x16x32_bf16 v[48:51], v[16:19], v[72:75], v[48:51]
v_perm_b32 v20, v198, v194, s101
v_perm_b32 v21, v206, v202, s101
v_perm_b32 v22, v214, v210, s101
v_perm_b32 v23, v222, v218, s101
    s_nop 1
v_mfma_f32_16x16x32_bf16 v[52:55], v[20:23], v[72:75], v[52:55]
v_perm_b32 v24, v199, v195, s100
v_perm_b32 v25, v207, v203, s100
v_perm_b32 v26, v215, v211, s100
v_perm_b32 v27, v223, v219, s100
    s_nop 1
v_mfma_f32_16x16x32_bf16 v[56:59], v[24:27], v[72:75], v[56:59]
v_perm_b32 v28, v199, v195, s101
v_perm_b32 v29, v207, v203, s101
v_perm_b32 v30, v215, v211, s101
v_perm_b32 v31, v223, v219, s101
    s_nop 1
v_mfma_f32_16x16x32_bf16 v[60:63], v[28:31], v[72:75], v[60:63]

    v_lshrrev_b32 v6, 1, v1
    s_and_b32 s8, s2, 31
    v_xor_b32 v6, s8, v6
    v_lshlrev_b32 v6, 3, v6
    v_lshrrev_b32 v7, 1, v10
    v_lshlrev_b32 v7, 8, v7
    v_add_u32 v6, v6, v7
    s_lshr_b32 s8, s2, 3
    s_lshl_b32 s8, s8, 9
    s_add_u32 s8, s8, 393216

s_waitcnt vmcnt(24)
buffer_load_dwordx2 a[0:1], v6, s[60:63], s8 offen sc1
s_mov_b32 s74, 49152
buffer_load_dwordx4 v[192:195], v8, s[48:51], s74 offen offset:0 nt
buffer_load_dwordx4 v[196:199], v8, s[48:51], s74 offen offset:1024 nt
buffer_load_dwordx4 v[200:203], v8, s[48:51], s74 offen offset:2048 nt
buffer_load_dwordx4 v[204:207], v8, s[48:51], s74 offen offset:3072 nt
buffer_load_dwordx4 v[208:211], v9, s[48:51], s74 offen offset:0 nt
buffer_load_dwordx4 v[212:215], v9, s[48:51], s74 offen offset:1024 nt
buffer_load_dwordx4 v[216:219], v9, s[48:51], s74 offen offset:2048 nt
buffer_load_dwordx4 v[220:223], v9, s[48:51], s74 offen offset:3072 nt
s_waitcnt vmcnt(25)
v_perm_b32 v16, v228, v224, s100
v_perm_b32 v17, v236, v232, s100
v_perm_b32 v18, v244, v240, s100
v_perm_b32 v19, v252, v248, s100
    s_nop 1
v_mfma_f32_16x16x32_bf16 v[32:35], v[16:19], v[76:79], v[32:35]
v_perm_b32 v20, v228, v224, s101
v_perm_b32 v21, v236, v232, s101
v_perm_b32 v22, v244, v240, s101
v_perm_b32 v23, v252, v248, s101
    s_nop 1
v_mfma_f32_16x16x32_bf16 v[36:39], v[20:23], v[76:79], v[36:39]
v_perm_b32 v24, v229, v225, s100
v_perm_b32 v25, v237, v233, s100
v_perm_b32 v26, v245, v241, s100
v_perm_b32 v27, v253, v249, s100
    s_nop 1
v_mfma_f32_16x16x32_bf16 v[40:43], v[24:27], v[76:79], v[40:43]
v_perm_b32 v28, v229, v225, s101
v_perm_b32 v29, v237, v233, s101
v_perm_b32 v30, v245, v241, s101
v_perm_b32 v31, v253, v249, s101
    s_nop 1
v_mfma_f32_16x16x32_bf16 v[44:47], v[28:31], v[76:79], v[44:47]
v_perm_b32 v16, v230, v226, s100
v_perm_b32 v17, v238, v234, s100
v_perm_b32 v18, v246, v242, s100
v_perm_b32 v19, v254, v250, s100
    s_nop 1
v_mfma_f32_16x16x32_bf16 v[48:51], v[16:19], v[76:79], v[48:51]
v_perm_b32 v20, v230, v226, s101
v_perm_b32 v21, v238, v234, s101
v_perm_b32 v22, v246, v242, s101
v_perm_b32 v23, v254, v250, s101
    s_nop 1
v_mfma_f32_16x16x32_bf16 v[52:55], v[20:23], v[76:79], v[52:55]
v_perm_b32 v24, v231, v227, s100
v_perm_b32 v25, v239, v235, s100
v_perm_b32 v26, v247, v243, s100
v_perm_b32 v27, v255, v251, s100
    s_nop 1
v_mfma_f32_16x16x32_bf16 v[56:59], v[24:27], v[76:79], v[56:59]
v_perm_b32 v28, v231, v227, s101
v_perm_b32 v29, v239, v235, s101
v_perm_b32 v30, v247, v243, s101
v_perm_b32 v31, v255, v251, s101
    s_nop 1
v_mfma_f32_16x16x32_bf16 v[60:63], v[28:31], v[76:79], v[60:63]
s_waitcnt vmcnt(24)
s_mov_b32 s74, 57344
buffer_load_dwordx4 v[224:227], v8, s[48:51], s74 offen offset:0 nt
buffer_load_dwordx4 v[228:231], v8, s[48:51], s74 offen offset:1024 nt
buffer_load_dwordx4 v[232:235], v8, s[48:51], s74 offen offset:2048 nt
buffer_load_dwordx4 v[236:239], v8, s[48:51], s74 offen offset:3072 nt
buffer_load_dwordx4 v[240:243], v9, s[48:51], s74 offen offset:0 nt
buffer_load_dwordx4 v[244:247], v9, s[48:51], s74 offen offset:1024 nt
buffer_load_dwordx4 v[248:251], v9, s[48:51], s74 offen offset:2048 nt
buffer_load_dwordx4 v[252:255], v9, s[48:51], s74 offen offset:3072 nt
s_waitcnt vmcnt(25)
v_perm_b32 v16, v132, v128, s100
v_perm_b32 v17, v140, v136, s100
v_perm_b32 v18, v148, v144, s100
v_perm_b32 v19, v156, v152, s100
    s_nop 1
v_mfma_f32_16x16x32_bf16 v[32:35], v[16:19], v[80:83], v[32:35]
v_perm_b32 v20, v132, v128, s101
v_perm_b32 v21, v140, v136, s101
v_perm_b32 v22, v148, v144, s101
v_perm_b32 v23, v156, v152, s101
    s_nop 1
v_mfma_f32_16x16x32_bf16 v[36:39], v[20:23], v[80:83], v[36:39]
v_perm_b32 v24, v133, v129, s100
v_perm_b32 v25, v141, v137, s100
v_perm_b32 v26, v149, v145, s100
v_perm_b32 v27, v157, v153, s100
    s_nop 1
v_mfma_f32_16x16x32_bf16 v[40:43], v[24:27], v[80:83], v[40:43]
v_perm_b32 v28, v133, v129, s101
v_perm_b32 v29, v141, v137, s101
v_perm_b32 v30, v149, v145, s101
v_perm_b32 v31, v157, v153, s101
    s_nop 1
v_mfma_f32_16x16x32_bf16 v[44:47], v[28:31], v[80:83], v[44:47]
v_perm_b32 v16, v134, v130, s100
v_perm_b32 v17, v142, v138, s100
v_perm_b32 v18, v150, v146, s100
v_perm_b32 v19, v158, v154, s100
    s_nop 1
v_mfma_f32_16x16x32_bf16 v[48:51], v[16:19], v[80:83], v[48:51]
v_perm_b32 v20, v134, v130, s101
v_perm_b32 v21, v142, v138, s101
v_perm_b32 v22, v150, v146, s101
v_perm_b32 v23, v158, v154, s101
    s_nop 1
v_mfma_f32_16x16x32_bf16 v[52:55], v[20:23], v[80:83], v[52:55]
v_perm_b32 v24, v135, v131, s100
v_perm_b32 v25, v143, v139, s100
v_perm_b32 v26, v151, v147, s100
v_perm_b32 v27, v159, v155, s100
    s_nop 1
v_mfma_f32_16x16x32_bf16 v[56:59], v[24:27], v[80:83], v[56:59]
v_perm_b32 v28, v135, v131, s101
v_perm_b32 v29, v143, v139, s101
v_perm_b32 v30, v151, v147, s101
v_perm_b32 v31, v159, v155, s101
    s_nop 1
v_mfma_f32_16x16x32_bf16 v[60:63], v[28:31], v[80:83], v[60:63]
s_waitcnt vmcnt(17)
v_perm_b32 v16, v164, v160, s100
v_perm_b32 v17, v172, v168, s100
v_perm_b32 v18, v180, v176, s100
v_perm_b32 v19, v188, v184, s100
    s_nop 1
v_mfma_f32_16x16x32_bf16 v[32:35], v[16:19], v[84:87], v[32:35]
v_perm_b32 v20, v164, v160, s101
v_perm_b32 v21, v172, v168, s101
v_perm_b32 v22, v180, v176, s101
v_perm_b32 v23, v188, v184, s101
    s_nop 1
v_mfma_f32_16x16x32_bf16 v[36:39], v[20:23], v[84:87], v[36:39]
v_perm_b32 v24, v165, v161, s100
v_perm_b32 v25, v173, v169, s100
v_perm_b32 v26, v181, v177, s100
v_perm_b32 v27, v189, v185, s100
    s_nop 1
v_mfma_f32_16x16x32_bf16 v[40:43], v[24:27], v[84:87], v[40:43]
v_perm_b32 v28, v165, v161, s101
v_perm_b32 v29, v173, v169, s101
v_perm_b32 v30, v181, v177, s101
v_perm_b32 v31, v189, v185, s101
    s_nop 1
v_mfma_f32_16x16x32_bf16 v[44:47], v[28:31], v[84:87], v[44:47]
v_perm_b32 v16, v166, v162, s100
v_perm_b32 v17, v174, v170, s100
v_perm_b32 v18, v182, v178, s100
v_perm_b32 v19, v190, v186, s100
    s_nop 1
v_mfma_f32_16x16x32_bf16 v[48:51], v[16:19], v[84:87], v[48:51]
v_perm_b32 v20, v166, v162, s101
v_perm_b32 v21, v174, v170, s101
v_perm_b32 v22, v182, v178, s101
v_perm_b32 v23, v190, v186, s101
    s_nop 1
v_mfma_f32_16x16x32_bf16 v[52:55], v[20:23], v[84:87], v[52:55]
v_perm_b32 v24, v167, v163, s100
v_perm_b32 v25, v175, v171, s100
v_perm_b32 v26, v183, v179, s100
v_perm_b32 v27, v191, v187, s100
    s_nop 1
v_mfma_f32_16x16x32_bf16 v[56:59], v[24:27], v[84:87], v[56:59]
v_perm_b32 v28, v167, v163, s101
v_perm_b32 v29, v175, v171, s101
v_perm_b32 v30, v183, v179, s101
v_perm_b32 v31, v191, v187, s101
    s_nop 1
v_mfma_f32_16x16x32_bf16 v[60:63], v[28:31], v[84:87], v[60:63]
v_lshlrev_b32 v120, 3, v0
s_mov_b32 s74, 0
buffer_load_dwordx2 v[128:129], v120, s[52:55], s74 offen nt
s_add_u32 s74, s74, 2048
buffer_load_dwordx2 v[130:131], v120, s[52:55], s74 offen nt
s_add_u32 s74, s74, 2048
buffer_load_dwordx2 v[132:133], v120, s[52:55], s74 offen nt
s_add_u32 s74, s74, 2048
buffer_load_dwordx2 v[134:135], v120, s[52:55], s74 offen nt
s_add_u32 s74, s74, 2048
buffer_load_dwordx2 v[136:137], v120, s[52:55], s74 offen nt
s_add_u32 s74, s74, 2048
buffer_load_dwordx2 v[138:139], v120, s[52:55], s74 offen nt
s_add_u32 s74, s74, 2048
buffer_load_dwordx2 v[140:141], v120, s[52:55], s74 offen nt
s_add_u32 s74, s74, 2048
buffer_load_dwordx2 v[142:143], v120, s[52:55], s74 offen nt
s_add_u32 s74, s74, 2048
buffer_load_dwordx2 v[144:145], v120, s[52:55], s74 offen nt
s_add_u32 s74, s74, 2048
buffer_load_dwordx2 v[146:147], v120, s[52:55], s74 offen nt
s_add_u32 s74, s74, 2048
buffer_load_dwordx2 v[148:149], v120, s[52:55], s74 offen nt
s_add_u32 s74, s74, 2048
buffer_load_dwordx2 v[150:151], v120, s[52:55], s74 offen nt
s_add_u32 s74, s74, 2048
buffer_load_dwordx2 v[152:153], v120, s[52:55], s74 offen nt
s_add_u32 s74, s74, 2048
buffer_load_dwordx2 v[154:155], v120, s[52:55], s74 offen nt
s_add_u32 s74, s74, 2048
buffer_load_dwordx2 v[156:157], v120, s[52:55], s74 offen nt
s_add_u32 s74, s74, 2048
buffer_load_dwordx2 v[158:159], v120, s[52:55], s74 offen nt
s_waitcnt vmcnt(32)

    v_accvgpr_read_b32 v96, a0
    v_accvgpr_read_b32 v97, a1
    s_mov_b32 s75, 0
L_mlspin:
    v_max_u32 v98, v96, v97
    v_cmp_eq_u32 vcc, -1, v98
    s_nop 1
    s_cmp_eq_u64 vcc, 0
    s_cbranch_scc1 L_mlok
    s_add_u32 s75, s75, 1
    s_cmp_gt_u32 s75, 20000
    s_cbranch_scc1 L_end
    buffer_load_dwordx2 v[96:97], v6, s[60:63], s8 offen sc1
    s_waitcnt vmcnt(0)
    s_branch L_mlspin
L_mlok:
    v_mov_b32 v98, v96

    s_nop 1
v_max_f32_dpp v98, v98, v98 row_ror:8 row_mask:0xf bank_mask:0xf
    s_nop 1
v_max_f32_dpp v98, v98, v98 row_ror:4 row_mask:0xf bank_mask:0xf
    s_nop 1
v_max_f32_dpp v98, v98, v98 row_ror:2 row_mask:0xf bank_mask:0xf
v_mov_b32 v104, v98
    s_nop 1
v_permlane16_swap_b32 v98, v104
v_max_f32 v98, v98, v104
v_mov_b32 v104, v98
    s_nop 1
v_permlane32_swap_b32 v98, v104
v_max_f32 v98, v98, v104
v_sub_f32 v98, v96, v98
v_mul_f32 v98, 0x3fb8aa3b, v98
v_exp_f32 v98, v98
    s_nop 0
v_mul_f32 v99, v98, v97
    s_nop 1
v_add_f32_dpp v99, v99, v99 row_ror:8 row_mask:0xf bank_mask:0xf
    s_nop 1
v_add_f32_dpp v99, v99, v99 row_ror:4 row_mask:0xf bank_mask:0xf
    s_nop 1
v_add_f32_dpp v99, v99, v99 row_ror:2 row_mask:0xf bank_mask:0xf
v_mov_b32 v104, v99
    s_nop 1
v_permlane16_swap_b32 v99, v104
v_add_f32 v99, v99, v104
v_mov_b32 v104, v99
    s_nop 1
v_permlane32_swap_b32 v99, v104
v_add_f32 v99, v99, v104

    v_rcp_f32 v100, v99
    s_nop 0
    v_mul_f32 v101, v98, v100
    v_fma_f32 v102, -v101, v99, v98
    v_fma_f32 v100, v102, v100, v101

    v_and_b32 v96, 15, v1
    v_mul_u32_u24 v96, 528, v96
    v_lshrrev_b32 v97, 4, v1
    v_lshlrev_b32 v97, 7, v97
    v_add_u32 v96, v96, v97
    v_mul_u32_u24 v97, 4224, v10
    v_add_u32 v96, v96, v97
    v_lshrrev_b32 v98, 5, v0
    v_mul_u32_u24 v97, 528, v98
    v_and_b32 v99, 31, v0
    v_lshlrev_b32 v101, 4, v99
    v_add_u32 v97, v97, v101
    v_lshlrev_b32 v98, 15, v98
    v_lshrrev_b32 v101, 2, v99
    v_lshlrev_b32 v101, 12, v101
    v_add_u32 v98, v98, v101
    v_and_b32 v101, 3, v99
    v_lshlrev_b32 v101, 4, v101
    v_add_u32 v98, v98, v101
    v_bfe_u32 v101, v0, 2, 5
    v_xor_b32 v101, s6, v101
    v_lshlrev_b32 v101, 6, v101
    v_add_u32 v98, v98, v101
    s_lshl_b32 s10, s5, 18
    s_lshl_b32 s73, s4, 11
    s_add_u32 s10, s10, s73
    s_add_u32 s10, s10, 1048576
    v_lshrrev_b32 v99, 1, v10
    v_lshlrev_b32 v99, 11, v99
    v_lshrrev_b32 v101, 1, v1
    v_lshlrev_b32 v101, 6, v101
    v_add_u32 v99, v99, v101
    v_and_b32 v101, 1, v10
    v_lshlrev_b32 v101, 5, v101
    v_add_u32 v99, v99, v101
    v_and_b32 v101, 1, v1
    v_lshlrev_b32 v101, 4, v101
    v_add_u32 v99, v99, v101
    s_lshl_b32 s11, s2, 12
    s_add_u32 s11, s11, 1048576
    v_and_b32 v101, 1, v10
    v_lshlrev_b32 v101, 6, v101
    v_and_b32 v102, 1, v1
    v_lshlrev_b32 v102, 5, v102
    v_add_u32 v101, v101, v102
    v_lshrrev_b32 v102, 4, v1
    v_lshlrev_b32 v102, 3, v102
    v_add_u32 v101, v101, v102
    v_lshrrev_b32 v102, 1, v10
    v_lshlrev_b32 v102, 2, v102
    v_add_u32 v101, v101, v102
    v_mov_b32 v102, 0
    v_lshrrev_b32 v103, 1, v0
    v_xor_b32 v11, s2, v103
    v_lshlrev_b32 v103, 13, v103
    v_and_b32 v104, 1, v0
    v_lshlrev_b32 v104, 4, v104
    v_add_u32 v103, v103, v104
    v_xor_b32 v109, 0x80, v11
    v_lshlrev_b32 v109, 5, v109
    v_add_u32 v109, v109, v103
    v_lshlrev_b32 v11, 5, v11
    v_add_u32 v103, v103, v11
    s_mov_b32 s96, 2097152
    s_mov_b32 s97, 3145728
    v_lshlrev_b32 v104, 5, v0
    s_lshl_b32 s98, s2, 13
    s_add_u32 s98, s98, 2097152
    v_lshlrev_b32 v105, 5, v10
    v_lshrrev_b32 v106, 4, v1
    v_lshlrev_b32 v106, 3, v106
    v_add_u32 v105, v105, v106
    v_lshlrev_b32 v106, 3, v1
    v_lshlrev_b32 v107, 2, v1
    v_and_b32 v107, 12, v107

buffer_load_dword v108, v107, s[28:31], s9 offen
s_waitcnt vmcnt(25)
v_perm_b32 v16, v196, v192, s100
v_perm_b32 v17, v204, v200, s100
v_perm_b32 v18, v212, v208, s100
v_perm_b32 v19, v220, v216, s100
    s_nop 1
v_mfma_f32_16x16x32_bf16 v[32:35], v[16:19], v[88:91], v[32:35]
v_perm_b32 v20, v196, v192, s101
v_perm_b32 v21, v204, v200, s101
v_perm_b32 v22, v212, v208, s101
v_perm_b32 v23, v220, v216, s101
    s_nop 1
v_mfma_f32_16x16x32_bf16 v[36:39], v[20:23], v[88:91], v[36:39]
v_perm_b32 v24, v197, v193, s100
v_perm_b32 v25, v205, v201, s100
v_perm_b32 v26, v213, v209, s100
v_perm_b32 v27, v221, v217, s100
    s_nop 1
v_mfma_f32_16x16x32_bf16 v[40:43], v[24:27], v[88:91], v[40:43]
v_perm_b32 v28, v197, v193, s101
v_perm_b32 v29, v205, v201, s101
v_perm_b32 v30, v213, v209, s101
v_perm_b32 v31, v221, v217, s101
    s_nop 1
v_mfma_f32_16x16x32_bf16 v[44:47], v[28:31], v[88:91], v[44:47]
v_perm_b32 v16, v198, v194, s100
v_perm_b32 v17, v206, v202, s100
v_perm_b32 v18, v214, v210, s100
v_perm_b32 v19, v222, v218, s100
    s_nop 1
v_mfma_f32_16x16x32_bf16 v[48:51], v[16:19], v[88:91], v[48:51]
v_perm_b32 v20, v198, v194, s101
v_perm_b32 v21, v206, v202, s101
v_perm_b32 v22, v214, v210, s101
v_perm_b32 v23, v222, v218, s101
    s_nop 1
v_mfma_f32_16x16x32_bf16 v[52:55], v[20:23], v[88:91], v[52:55]
v_perm_b32 v24, v199, v195, s100
v_perm_b32 v25, v207, v203, s100
v_perm_b32 v26, v215, v211, s100
v_perm_b32 v27, v223, v219, s100
    s_nop 1
v_mfma_f32_16x16x32_bf16 v[56:59], v[24:27], v[88:91], v[56:59]
v_perm_b32 v28, v199, v195, s101
v_perm_b32 v29, v207, v203, s101
v_perm_b32 v30, v215, v211, s101
v_perm_b32 v31, v223, v219, s101
    s_nop 1
v_mfma_f32_16x16x32_bf16 v[60:63], v[28:31], v[88:91], v[60:63]
v_lshlrev_b32 v120, 3, v0
s_mov_b32 s74, 0
buffer_load_dwordx2 v[160:161], v120, s[56:59], s74 offen nt
s_mov_b32 s74, 16384
buffer_load_dwordx2 v[162:163], v120, s[56:59], s74 offen nt
s_mov_b32 s74, 32768
buffer_load_dwordx2 v[164:165], v120, s[56:59], s74 offen nt
s_mov_b32 s74, 49152
buffer_load_dwordx2 v[166:167], v120, s[56:59], s74 offen nt
s_mov_b32 s74, 2048
buffer_load_dwordx2 v[168:169], v120, s[56:59], s74 offen nt
s_mov_b32 s74, 18432
buffer_load_dwordx2 v[170:171], v120, s[56:59], s74 offen nt
s_mov_b32 s74, 34816
buffer_load_dwordx2 v[172:173], v120, s[56:59], s74 offen nt
s_mov_b32 s74, 51200
buffer_load_dwordx2 v[174:175], v120, s[56:59], s74 offen nt
s_mov_b32 s74, 4096
buffer_load_dwordx2 v[176:177], v120, s[56:59], s74 offen nt
s_mov_b32 s74, 20480
buffer_load_dwordx2 v[178:179], v120, s[56:59], s74 offen nt
s_mov_b32 s74, 36864
buffer_load_dwordx2 v[180:181], v120, s[56:59], s74 offen nt
s_mov_b32 s74, 53248
buffer_load_dwordx2 v[182:183], v120, s[56:59], s74 offen nt
s_mov_b32 s74, 6144
buffer_load_dwordx2 v[184:185], v120, s[56:59], s74 offen nt
s_mov_b32 s74, 22528
buffer_load_dwordx2 v[186:187], v120, s[56:59], s74 offen nt
s_mov_b32 s74, 38912
buffer_load_dwordx2 v[188:189], v120, s[56:59], s74 offen nt
s_mov_b32 s74, 55296
buffer_load_dwordx2 v[190:191], v120, s[56:59], s74 offen nt
s_waitcnt vmcnt(33)
v_perm_b32 v16, v228, v224, s100
v_perm_b32 v17, v236, v232, s100
v_perm_b32 v18, v244, v240, s100
v_perm_b32 v19, v252, v248, s100
    s_nop 1
v_mfma_f32_16x16x32_bf16 v[32:35], v[16:19], v[92:95], v[32:35]
v_perm_b32 v20, v228, v224, s101
v_perm_b32 v21, v236, v232, s101
v_perm_b32 v22, v244, v240, s101
v_perm_b32 v23, v252, v248, s101
    s_nop 1
v_mfma_f32_16x16x32_bf16 v[36:39], v[20:23], v[92:95], v[36:39]
v_perm_b32 v24, v229, v225, s100
v_perm_b32 v25, v237, v233, s100
v_perm_b32 v26, v245, v241, s100
v_perm_b32 v27, v253, v249, s100
    s_nop 1
v_mfma_f32_16x16x32_bf16 v[40:43], v[24:27], v[92:95], v[40:43]
v_perm_b32 v28, v229, v225, s101
v_perm_b32 v29, v237, v233, s101
v_perm_b32 v30, v245, v241, s101
v_perm_b32 v31, v253, v249, s101
    s_nop 1
v_mfma_f32_16x16x32_bf16 v[44:47], v[28:31], v[92:95], v[44:47]
v_perm_b32 v16, v230, v226, s100
v_perm_b32 v17, v238, v234, s100
v_perm_b32 v18, v246, v242, s100
v_perm_b32 v19, v254, v250, s100
    s_nop 1
v_mfma_f32_16x16x32_bf16 v[48:51], v[16:19], v[92:95], v[48:51]
v_perm_b32 v20, v230, v226, s101
v_perm_b32 v21, v238, v234, s101
v_perm_b32 v22, v246, v242, s101
v_perm_b32 v23, v254, v250, s101
    s_nop 1
v_mfma_f32_16x16x32_bf16 v[52:55], v[20:23], v[92:95], v[52:55]
v_perm_b32 v24, v231, v227, s100
v_perm_b32 v25, v239, v235, s100
v_perm_b32 v26, v247, v243, s100
v_perm_b32 v27, v255, v251, s100
    s_nop 1
v_mfma_f32_16x16x32_bf16 v[56:59], v[24:27], v[92:95], v[56:59]
v_perm_b32 v28, v231, v227, s101
v_perm_b32 v29, v239, v235, s101
v_perm_b32 v30, v247, v243, s101
v_perm_b32 v31, v255, v251, s101
    s_nop 1
v_mfma_f32_16x16x32_bf16 v[60:63], v[28:31], v[92:95], v[60:63]
s_mov_b32 exec_lo, 0x00ff00ff
s_mov_b32 exec_hi, 0x00ff00ff
ds_write_b128 v96, v[32:35] offset:2560
ds_write_b128 v96, v[36:39] offset:2576
ds_write_b128 v96, v[40:43] offset:2592
ds_write_b128 v96, v[44:47] offset:2608
ds_write_b128 v96, v[48:51] offset:2624
ds_write_b128 v96, v[52:55] offset:2640
ds_write_b128 v96, v[56:59] offset:2656
ds_write_b128 v96, v[60:63] offset:2672
s_mov_b64 exec, -1
s_waitcnt lgkmcnt(0)
s_barrier
ds_read_b128 v[16:19], v97 offset:2560
ds_read_b128 v[20:23], v97 offset:6784
ds_read_b128 v[24:27], v97 offset:11008
ds_read_b128 v[28:31], v97 offset:15232
s_waitcnt lgkmcnt(2)
v_pk_add_f32 v[16:17], v[16:17], v[20:21]
v_pk_add_f32 v[18:19], v[18:19], v[22:23]
s_waitcnt lgkmcnt(0)
v_pk_add_f32 v[24:25], v[24:25], v[28:29]
v_pk_add_f32 v[26:27], v[26:27], v[30:31]
v_pk_add_f32 v[16:17], v[16:17], v[24:25]
v_pk_add_f32 v[18:19], v[18:19], v[26:27]
buffer_store_dwordx4 v[16:19], v98, s[60:63], s10 offen sc1
    s_nop 1
v_mov_b32 v16, 0
ds_read_b128 v[64:67], v16 offset:1536
ds_read_b128 v[68:71], v16 offset:1552
ds_read_b128 v[72:75], v16 offset:1568
ds_read_b128 v[76:79], v16 offset:1584
ds_read_b128 v[80:83], v16 offset:1600
ds_read_b128 v[84:87], v16 offset:1616
ds_read_b128 v[88:91], v16 offset:1632
ds_read_b128 v[92:95], v16 offset:1648
s_waitcnt vmcnt(18)
s_waitcnt lgkmcnt(0)
v_lshlrev_b32 v112, 16, v128
v_and_b32 v113, s72, v128
v_lshlrev_b32 v114, 16, v129
v_and_b32 v115, s72, v129
v_pk_mul_f32 v[2:3], v[112:113], v[64:65] op_sel:[0,0] op_sel_hi:[1,0]
v_pk_mul_f32 v[4:5], v[114:115], v[64:65] op_sel:[0,0] op_sel_hi:[1,0]
v_pk_mul_f32 v[12:13], v[112:113], v[64:65] op_sel:[0,1] op_sel_hi:[1,1]
v_pk_mul_f32 v[14:15], v[114:115], v[64:65] op_sel:[0,1] op_sel_hi:[1,1]
v_lshlrev_b32 v116, 16, v130
v_and_b32 v117, s72, v130
v_lshlrev_b32 v118, 16, v131
v_and_b32 v119, s72, v131
v_pk_fma_f32 v[2:3], v[116:117], v[66:67], v[2:3] op_sel:[0,0,0] op_sel_hi:[1,0,1]
v_pk_fma_f32 v[4:5], v[118:119], v[66:67], v[4:5] op_sel:[0,0,0] op_sel_hi:[1,0,1]
v_pk_fma_f32 v[12:13], v[116:117], v[66:67], v[12:13] op_sel:[0,1,0] op_sel_hi:[1,1,1]
v_pk_fma_f32 v[14:15], v[118:119], v[66:67], v[14:15] op_sel:[0,1,0] op_sel_hi:[1,1,1]
v_lshlrev_b32 v112, 16, v132
v_and_b32 v113, s72, v132
v_lshlrev_b32 v114, 16, v133
v_and_b32 v115, s72, v133
v_pk_fma_f32 v[2:3], v[112:113], v[68:69], v[2:3] op_sel:[0,0,0] op_sel_hi:[1,0,1]
v_pk_fma_f32 v[4:5], v[114:115], v[68:69], v[4:5] op_sel:[0,0,0] op_sel_hi:[1,0,1]
v_pk_fma_f32 v[12:13], v[112:113], v[68:69], v[12:13] op_sel:[0,1,0] op_sel_hi:[1,1,1]
v_pk_fma_f32 v[14:15], v[114:115], v[68:69], v[14:15] op_sel:[0,1,0] op_sel_hi:[1,1,1]
v_lshlrev_b32 v116, 16, v134
v_and_b32 v117, s72, v134
v_lshlrev_b32 v118, 16, v135
v_and_b32 v119, s72, v135
v_pk_fma_f32 v[2:3], v[116:117], v[70:71], v[2:3] op_sel:[0,0,0] op_sel_hi:[1,0,1]
v_pk_fma_f32 v[4:5], v[118:119], v[70:71], v[4:5] op_sel:[0,0,0] op_sel_hi:[1,0,1]
v_pk_fma_f32 v[12:13], v[116:117], v[70:71], v[12:13] op_sel:[0,1,0] op_sel_hi:[1,1,1]
v_pk_fma_f32 v[14:15], v[118:119], v[70:71], v[14:15] op_sel:[0,1,0] op_sel_hi:[1,1,1]
v_lshlrev_b32 v112, 16, v136
v_and_b32 v113, s72, v136
v_lshlrev_b32 v114, 16, v137
v_and_b32 v115, s72, v137
v_pk_fma_f32 v[2:3], v[112:113], v[72:73], v[2:3] op_sel:[0,0,0] op_sel_hi:[1,0,1]
v_pk_fma_f32 v[4:5], v[114:115], v[72:73], v[4:5] op_sel:[0,0,0] op_sel_hi:[1,0,1]
v_pk_fma_f32 v[12:13], v[112:113], v[72:73], v[12:13] op_sel:[0,1,0] op_sel_hi:[1,1,1]
v_pk_fma_f32 v[14:15], v[114:115], v[72:73], v[14:15] op_sel:[0,1,0] op_sel_hi:[1,1,1]
v_lshlrev_b32 v116, 16, v138
v_and_b32 v117, s72, v138
v_lshlrev_b32 v118, 16, v139
v_and_b32 v119, s72, v139
v_pk_fma_f32 v[2:3], v[116:117], v[74:75], v[2:3] op_sel:[0,0,0] op_sel_hi:[1,0,1]
v_pk_fma_f32 v[4:5], v[118:119], v[74:75], v[4:5] op_sel:[0,0,0] op_sel_hi:[1,0,1]
v_pk_fma_f32 v[12:13], v[116:117], v[74:75], v[12:13] op_sel:[0,1,0] op_sel_hi:[1,1,1]
v_pk_fma_f32 v[14:15], v[118:119], v[74:75], v[14:15] op_sel:[0,1,0] op_sel_hi:[1,1,1]
v_lshlrev_b32 v112, 16, v140
v_and_b32 v113, s72, v140
v_lshlrev_b32 v114, 16, v141
v_and_b32 v115, s72, v141
v_pk_fma_f32 v[2:3], v[112:113], v[76:77], v[2:3] op_sel:[0,0,0] op_sel_hi:[1,0,1]
v_pk_fma_f32 v[4:5], v[114:115], v[76:77], v[4:5] op_sel:[0,0,0] op_sel_hi:[1,0,1]
v_pk_fma_f32 v[12:13], v[112:113], v[76:77], v[12:13] op_sel:[0,1,0] op_sel_hi:[1,1,1]
v_pk_fma_f32 v[14:15], v[114:115], v[76:77], v[14:15] op_sel:[0,1,0] op_sel_hi:[1,1,1]
v_lshlrev_b32 v116, 16, v142
v_and_b32 v117, s72, v142
v_lshlrev_b32 v118, 16, v143
v_and_b32 v119, s72, v143
v_pk_fma_f32 v[2:3], v[116:117], v[78:79], v[2:3] op_sel:[0,0,0] op_sel_hi:[1,0,1]
v_pk_fma_f32 v[4:5], v[118:119], v[78:79], v[4:5] op_sel:[0,0,0] op_sel_hi:[1,0,1]
v_pk_fma_f32 v[12:13], v[116:117], v[78:79], v[12:13] op_sel:[0,1,0] op_sel_hi:[1,1,1]
v_pk_fma_f32 v[14:15], v[118:119], v[78:79], v[14:15] op_sel:[0,1,0] op_sel_hi:[1,1,1]
v_lshlrev_b32 v112, 16, v144
v_and_b32 v113, s72, v144
v_lshlrev_b32 v114, 16, v145
v_and_b32 v115, s72, v145
v_pk_fma_f32 v[2:3], v[112:113], v[80:81], v[2:3] op_sel:[0,0,0] op_sel_hi:[1,0,1]
v_pk_fma_f32 v[4:5], v[114:115], v[80:81], v[4:5] op_sel:[0,0,0] op_sel_hi:[1,0,1]
v_pk_fma_f32 v[12:13], v[112:113], v[80:81], v[12:13] op_sel:[0,1,0] op_sel_hi:[1,1,1]
v_pk_fma_f32 v[14:15], v[114:115], v[80:81], v[14:15] op_sel:[0,1,0] op_sel_hi:[1,1,1]
v_lshlrev_b32 v116, 16, v146
v_and_b32 v117, s72, v146
v_lshlrev_b32 v118, 16, v147
v_and_b32 v119, s72, v147
v_pk_fma_f32 v[2:3], v[116:117], v[82:83], v[2:3] op_sel:[0,0,0] op_sel_hi:[1,0,1]
v_pk_fma_f32 v[4:5], v[118:119], v[82:83], v[4:5] op_sel:[0,0,0] op_sel_hi:[1,0,1]
v_pk_fma_f32 v[12:13], v[116:117], v[82:83], v[12:13] op_sel:[0,1,0] op_sel_hi:[1,1,1]
v_pk_fma_f32 v[14:15], v[118:119], v[82:83], v[14:15] op_sel:[0,1,0] op_sel_hi:[1,1,1]
v_lshlrev_b32 v112, 16, v148
v_and_b32 v113, s72, v148
v_lshlrev_b32 v114, 16, v149
v_and_b32 v115, s72, v149
v_pk_fma_f32 v[2:3], v[112:113], v[84:85], v[2:3] op_sel:[0,0,0] op_sel_hi:[1,0,1]
v_pk_fma_f32 v[4:5], v[114:115], v[84:85], v[4:5] op_sel:[0,0,0] op_sel_hi:[1,0,1]
v_pk_fma_f32 v[12:13], v[112:113], v[84:85], v[12:13] op_sel:[0,1,0] op_sel_hi:[1,1,1]
v_pk_fma_f32 v[14:15], v[114:115], v[84:85], v[14:15] op_sel:[0,1,0] op_sel_hi:[1,1,1]
v_lshlrev_b32 v116, 16, v150
v_and_b32 v117, s72, v150
v_lshlrev_b32 v118, 16, v151
v_and_b32 v119, s72, v151
v_pk_fma_f32 v[2:3], v[116:117], v[86:87], v[2:3] op_sel:[0,0,0] op_sel_hi:[1,0,1]
v_pk_fma_f32 v[4:5], v[118:119], v[86:87], v[4:5] op_sel:[0,0,0] op_sel_hi:[1,0,1]
v_pk_fma_f32 v[12:13], v[116:117], v[86:87], v[12:13] op_sel:[0,1,0] op_sel_hi:[1,1,1]
v_pk_fma_f32 v[14:15], v[118:119], v[86:87], v[14:15] op_sel:[0,1,0] op_sel_hi:[1,1,1]
v_lshlrev_b32 v112, 16, v152
v_and_b32 v113, s72, v152
v_lshlrev_b32 v114, 16, v153
v_and_b32 v115, s72, v153
v_pk_fma_f32 v[2:3], v[112:113], v[88:89], v[2:3] op_sel:[0,0,0] op_sel_hi:[1,0,1]
v_pk_fma_f32 v[4:5], v[114:115], v[88:89], v[4:5] op_sel:[0,0,0] op_sel_hi:[1,0,1]
v_pk_fma_f32 v[12:13], v[112:113], v[88:89], v[12:13] op_sel:[0,1,0] op_sel_hi:[1,1,1]
v_pk_fma_f32 v[14:15], v[114:115], v[88:89], v[14:15] op_sel:[0,1,0] op_sel_hi:[1,1,1]
v_lshlrev_b32 v116, 16, v154
v_and_b32 v117, s72, v154
v_lshlrev_b32 v118, 16, v155
v_and_b32 v119, s72, v155
v_pk_fma_f32 v[2:3], v[116:117], v[90:91], v[2:3] op_sel:[0,0,0] op_sel_hi:[1,0,1]
v_pk_fma_f32 v[4:5], v[118:119], v[90:91], v[4:5] op_sel:[0,0,0] op_sel_hi:[1,0,1]
v_pk_fma_f32 v[12:13], v[116:117], v[90:91], v[12:13] op_sel:[0,1,0] op_sel_hi:[1,1,1]
v_pk_fma_f32 v[14:15], v[118:119], v[90:91], v[14:15] op_sel:[0,1,0] op_sel_hi:[1,1,1]
v_lshlrev_b32 v112, 16, v156
v_and_b32 v113, s72, v156
v_lshlrev_b32 v114, 16, v157
v_and_b32 v115, s72, v157
v_pk_fma_f32 v[2:3], v[112:113], v[92:93], v[2:3] op_sel:[0,0,0] op_sel_hi:[1,0,1]
v_pk_fma_f32 v[4:5], v[114:115], v[92:93], v[4:5] op_sel:[0,0,0] op_sel_hi:[1,0,1]
v_pk_fma_f32 v[12:13], v[112:113], v[92:93], v[12:13] op_sel:[0,1,0] op_sel_hi:[1,1,1]
v_pk_fma_f32 v[14:15], v[114:115], v[92:93], v[14:15] op_sel:[0,1,0] op_sel_hi:[1,1,1]
v_lshlrev_b32 v116, 16, v158
v_and_b32 v117, s72, v158
v_lshlrev_b32 v118, 16, v159
v_and_b32 v119, s72, v159
v_pk_fma_f32 v[2:3], v[116:117], v[94:95], v[2:3] op_sel:[0,0,0] op_sel_hi:[1,0,1]
v_pk_fma_f32 v[4:5], v[118:119], v[94:95], v[4:5] op_sel:[0,0,0] op_sel_hi:[1,0,1]
v_pk_fma_f32 v[12:13], v[116:117], v[94:95], v[12:13] op_sel:[0,1,0] op_sel_hi:[1,1,1]
v_pk_fma_f32 v[14:15], v[118:119], v[94:95], v[14:15] op_sel:[0,1,0] op_sel_hi:[1,1,1]
buffer_load_dwordx4 v[20:23], v99, s[60:63], s11 offen sc1
s_waitcnt vmcnt(10)
v_lshlrev_b32 v192, 16, v160
v_and_b32 v193, s72, v160
v_lshlrev_b32 v194, 16, v161
v_and_b32 v195, s72, v161
v_lshlrev_b32 v196, 16, v162
v_and_b32 v197, s72, v162
v_lshlrev_b32 v198, 16, v163
v_and_b32 v199, s72, v163
v_lshlrev_b32 v200, 16, v164
v_and_b32 v201, s72, v164
v_lshlrev_b32 v202, 16, v165
v_and_b32 v203, s72, v165
v_lshlrev_b32 v204, 16, v166
v_and_b32 v205, s72, v166
v_lshlrev_b32 v206, 16, v167
v_and_b32 v207, s72, v167
v_lshlrev_b32 v208, 16, v168
v_and_b32 v209, s72, v168
v_lshlrev_b32 v210, 16, v169
v_and_b32 v211, s72, v169
v_lshlrev_b32 v212, 16, v170
v_and_b32 v213, s72, v170
v_lshlrev_b32 v214, 16, v171
v_and_b32 v215, s72, v171
v_lshlrev_b32 v216, 16, v172
v_and_b32 v217, s72, v172
v_lshlrev_b32 v218, 16, v173
v_and_b32 v219, s72, v173
v_lshlrev_b32 v220, 16, v174
v_and_b32 v221, s72, v174
v_lshlrev_b32 v222, 16, v175
v_and_b32 v223, s72, v175
s_waitcnt vmcnt(2)
v_lshlrev_b32 v224, 16, v176
v_and_b32 v225, s72, v176
v_lshlrev_b32 v226, 16, v177
v_and_b32 v227, s72, v177
v_lshlrev_b32 v228, 16, v178
v_and_b32 v229, s72, v178
v_lshlrev_b32 v230, 16, v179
v_and_b32 v231, s72, v179
v_lshlrev_b32 v232, 16, v180
v_and_b32 v233, s72, v180
v_lshlrev_b32 v234, 16, v181
v_and_b32 v235, s72, v181
v_lshlrev_b32 v236, 16, v182
v_and_b32 v237, s72, v182
v_lshlrev_b32 v238, 16, v183
v_and_b32 v239, s72, v183
v_lshlrev_b32 v240, 16, v184
v_and_b32 v241, s72, v184
v_lshlrev_b32 v242, 16, v185
v_and_b32 v243, s72, v185
v_lshlrev_b32 v244, 16, v186
v_and_b32 v245, s72, v186
v_lshlrev_b32 v246, 16, v187
v_and_b32 v247, s72, v187
v_lshlrev_b32 v248, 16, v188
v_and_b32 v249, s72, v188
v_lshlrev_b32 v250, 16, v189
v_and_b32 v251, s72, v189
v_lshlrev_b32 v252, 16, v190
v_and_b32 v253, s72, v190
v_lshlrev_b32 v254, 16, v191
v_and_b32 v255, s72, v191
v_lshlrev_b32 v110, 16, v108
v_and_b32 v111, s72, v108
s_waitcnt vmcnt(0)

    s_mov_b32 s75, 0
    v_max3_u32 v24, v20, v21, v22
    v_max_u32 v24, v24, v23
    v_cmp_eq_u32 vcc, -1, v24
    s_nop 1
    s_cmp_eq_u64 vcc, 0
    s_cbranch_scc1 L_podone

s_waitcnt vmcnt(0)
s_mov_b32 s75, 0

    s_mov_b64 exec, 1
L_popre:
    buffer_load_dword v20, v99, s[60:63], s11 offen sc1
    s_add_u32 s75, s75, 1
    s_cmp_gt_u32 s75, 20000
    s_cbranch_scc1 L_end
    s_waitcnt vmcnt(0)
    v_cmp_eq_u32 vcc, -1, v20
    s_nop 1
    s_and_b64 exec, exec, vcc
    s_cbranch_execnz L_popre
    s_mov_b64 exec, -1

L_pospin:
    buffer_load_dwordx4 v[20:23], v99, s[60:63], s11 offen sc1
    s_add_u32 s75, s75, 1
    s_cmp_gt_u32 s75, 20000
    s_cbranch_scc1 L_end
    s_waitcnt vmcnt(0)
    v_max3_u32 v24, v20, v21, v22
    v_max_u32 v24, v24, v23
    v_cmp_eq_u32 vcc, -1, v24

    s_nop 1
    s_cmp_eq_u64 vcc, 0
    s_cbranch_scc0 L_pospin

L_podone:
v_pk_mul_f32 v[20:21], v[20:21], v[100:101] op_sel:[0,0] op_sel_hi:[1,0]
v_pk_mul_f32 v[22:23], v[22:23], v[100:101] op_sel:[0,0] op_sel_hi:[1,0]
    s_nop 1
v_permlane32_swap_b32 v20, v22
v_permlane32_swap_b32 v21, v23
v_add_f32 v20, v20, v22
v_add_f32 v21, v21, v23
    s_nop 1
v_permlane16_swap_b32 v20, v21
v_add_f32 v20, v20, v21
    s_nop 1
v_add_f32_dpp v20, v20, v20 row_ror:2 row_mask:0xf bank_mask:0xf
    s_nop 1
v_add_f32_dpp v20, v20, v20 row_ror:4 row_mask:0xf bank_mask:0xf
    s_nop 1
v_add_f32_dpp v20, v20, v20 row_ror:8 row_mask:0xf bank_mask:0xf
v_cvt_pk_bf16_f32 v20, v20, v20
v_and_b32 v20, s72, v20
s_mov_b32 exec_lo, 0x00030003
s_mov_b32 exec_hi, 0x00030003
ds_write_b32 v101, v20 offset:2176
s_mov_b64 exec, -1
s_waitcnt lgkmcnt(0)
s_barrier
ds_read_b128 v[16:19], v102 offset:2176
ds_read_b128 v[20:23], v102 offset:2192
ds_read_b128 v[24:27], v102 offset:2208
ds_read_b128 v[28:31], v102 offset:2224
ds_read_b128 v[32:35], v102 offset:2240
ds_read_b128 v[36:39], v102 offset:2256
ds_read_b128 v[40:43], v102 offset:2272
ds_read_b128 v[44:47], v102 offset:2288
s_waitcnt lgkmcnt(7)
v_pk_fma_f32 v[2:3], v[192:193], v[16:17], v[2:3] op_sel:[0,0,0] op_sel_hi:[1,0,1]
v_pk_fma_f32 v[4:5], v[194:195], v[16:17], v[4:5] op_sel:[0,0,0] op_sel_hi:[1,0,1]
v_pk_fma_f32 v[12:13], v[192:193], v[16:17], v[12:13] op_sel:[0,1,0] op_sel_hi:[1,1,1]
v_pk_fma_f32 v[14:15], v[194:195], v[16:17], v[14:15] op_sel:[0,1,0] op_sel_hi:[1,1,1]
v_pk_fma_f32 v[2:3], v[196:197], v[18:19], v[2:3] op_sel:[0,0,0] op_sel_hi:[1,0,1]
v_pk_fma_f32 v[4:5], v[198:199], v[18:19], v[4:5] op_sel:[0,0,0] op_sel_hi:[1,0,1]
v_pk_fma_f32 v[12:13], v[196:197], v[18:19], v[12:13] op_sel:[0,1,0] op_sel_hi:[1,1,1]
v_pk_fma_f32 v[14:15], v[198:199], v[18:19], v[14:15] op_sel:[0,1,0] op_sel_hi:[1,1,1]
s_waitcnt lgkmcnt(6)
v_pk_fma_f32 v[2:3], v[200:201], v[20:21], v[2:3] op_sel:[0,0,0] op_sel_hi:[1,0,1]
v_pk_fma_f32 v[4:5], v[202:203], v[20:21], v[4:5] op_sel:[0,0,0] op_sel_hi:[1,0,1]
v_pk_fma_f32 v[12:13], v[200:201], v[20:21], v[12:13] op_sel:[0,1,0] op_sel_hi:[1,1,1]
v_pk_fma_f32 v[14:15], v[202:203], v[20:21], v[14:15] op_sel:[0,1,0] op_sel_hi:[1,1,1]
v_pk_fma_f32 v[2:3], v[204:205], v[22:23], v[2:3] op_sel:[0,0,0] op_sel_hi:[1,0,1]
v_pk_fma_f32 v[4:5], v[206:207], v[22:23], v[4:5] op_sel:[0,0,0] op_sel_hi:[1,0,1]
v_pk_fma_f32 v[12:13], v[204:205], v[22:23], v[12:13] op_sel:[0,1,0] op_sel_hi:[1,1,1]
v_pk_fma_f32 v[14:15], v[206:207], v[22:23], v[14:15] op_sel:[0,1,0] op_sel_hi:[1,1,1]
s_waitcnt lgkmcnt(5)
v_pk_fma_f32 v[2:3], v[208:209], v[24:25], v[2:3] op_sel:[0,0,0] op_sel_hi:[1,0,1]
v_pk_fma_f32 v[4:5], v[210:211], v[24:25], v[4:5] op_sel:[0,0,0] op_sel_hi:[1,0,1]
v_pk_fma_f32 v[12:13], v[208:209], v[24:25], v[12:13] op_sel:[0,1,0] op_sel_hi:[1,1,1]
v_pk_fma_f32 v[14:15], v[210:211], v[24:25], v[14:15] op_sel:[0,1,0] op_sel_hi:[1,1,1]
v_pk_fma_f32 v[2:3], v[212:213], v[26:27], v[2:3] op_sel:[0,0,0] op_sel_hi:[1,0,1]
v_pk_fma_f32 v[4:5], v[214:215], v[26:27], v[4:5] op_sel:[0,0,0] op_sel_hi:[1,0,1]
v_pk_fma_f32 v[12:13], v[212:213], v[26:27], v[12:13] op_sel:[0,1,0] op_sel_hi:[1,1,1]
v_pk_fma_f32 v[14:15], v[214:215], v[26:27], v[14:15] op_sel:[0,1,0] op_sel_hi:[1,1,1]
s_waitcnt lgkmcnt(4)
v_pk_fma_f32 v[2:3], v[216:217], v[28:29], v[2:3] op_sel:[0,0,0] op_sel_hi:[1,0,1]
v_pk_fma_f32 v[4:5], v[218:219], v[28:29], v[4:5] op_sel:[0,0,0] op_sel_hi:[1,0,1]
v_pk_fma_f32 v[12:13], v[216:217], v[28:29], v[12:13] op_sel:[0,1,0] op_sel_hi:[1,1,1]
v_pk_fma_f32 v[14:15], v[218:219], v[28:29], v[14:15] op_sel:[0,1,0] op_sel_hi:[1,1,1]
v_pk_fma_f32 v[2:3], v[220:221], v[30:31], v[2:3] op_sel:[0,0,0] op_sel_hi:[1,0,1]
v_pk_fma_f32 v[4:5], v[222:223], v[30:31], v[4:5] op_sel:[0,0,0] op_sel_hi:[1,0,1]
v_pk_fma_f32 v[12:13], v[220:221], v[30:31], v[12:13] op_sel:[0,1,0] op_sel_hi:[1,1,1]
v_pk_fma_f32 v[14:15], v[222:223], v[30:31], v[14:15] op_sel:[0,1,0] op_sel_hi:[1,1,1]
s_waitcnt lgkmcnt(3)
v_pk_fma_f32 v[2:3], v[224:225], v[32:33], v[2:3] op_sel:[0,0,0] op_sel_hi:[1,0,1]
v_pk_fma_f32 v[4:5], v[226:227], v[32:33], v[4:5] op_sel:[0,0,0] op_sel_hi:[1,0,1]
v_pk_fma_f32 v[12:13], v[224:225], v[32:33], v[12:13] op_sel:[0,1,0] op_sel_hi:[1,1,1]
v_pk_fma_f32 v[14:15], v[226:227], v[32:33], v[14:15] op_sel:[0,1,0] op_sel_hi:[1,1,1]
v_pk_fma_f32 v[2:3], v[228:229], v[34:35], v[2:3] op_sel:[0,0,0] op_sel_hi:[1,0,1]
v_pk_fma_f32 v[4:5], v[230:231], v[34:35], v[4:5] op_sel:[0,0,0] op_sel_hi:[1,0,1]
v_pk_fma_f32 v[12:13], v[228:229], v[34:35], v[12:13] op_sel:[0,1,0] op_sel_hi:[1,1,1]
v_pk_fma_f32 v[14:15], v[230:231], v[34:35], v[14:15] op_sel:[0,1,0] op_sel_hi:[1,1,1]
s_waitcnt lgkmcnt(2)
v_pk_fma_f32 v[2:3], v[232:233], v[36:37], v[2:3] op_sel:[0,0,0] op_sel_hi:[1,0,1]
v_pk_fma_f32 v[4:5], v[234:235], v[36:37], v[4:5] op_sel:[0,0,0] op_sel_hi:[1,0,1]
v_pk_fma_f32 v[12:13], v[232:233], v[36:37], v[12:13] op_sel:[0,1,0] op_sel_hi:[1,1,1]
v_pk_fma_f32 v[14:15], v[234:235], v[36:37], v[14:15] op_sel:[0,1,0] op_sel_hi:[1,1,1]
v_pk_fma_f32 v[2:3], v[236:237], v[38:39], v[2:3] op_sel:[0,0,0] op_sel_hi:[1,0,1]
v_pk_fma_f32 v[4:5], v[238:239], v[38:39], v[4:5] op_sel:[0,0,0] op_sel_hi:[1,0,1]
v_pk_fma_f32 v[12:13], v[236:237], v[38:39], v[12:13] op_sel:[0,1,0] op_sel_hi:[1,1,1]
v_pk_fma_f32 v[14:15], v[238:239], v[38:39], v[14:15] op_sel:[0,1,0] op_sel_hi:[1,1,1]
s_waitcnt lgkmcnt(1)
v_pk_fma_f32 v[2:3], v[240:241], v[40:41], v[2:3] op_sel:[0,0,0] op_sel_hi:[1,0,1]
v_pk_fma_f32 v[4:5], v[242:243], v[40:41], v[4:5] op_sel:[0,0,0] op_sel_hi:[1,0,1]
v_pk_fma_f32 v[12:13], v[240:241], v[40:41], v[12:13] op_sel:[0,1,0] op_sel_hi:[1,1,1]
v_pk_fma_f32 v[14:15], v[242:243], v[40:41], v[14:15] op_sel:[0,1,0] op_sel_hi:[1,1,1]
v_pk_fma_f32 v[2:3], v[244:245], v[42:43], v[2:3] op_sel:[0,0,0] op_sel_hi:[1,0,1]
v_pk_fma_f32 v[4:5], v[246:247], v[42:43], v[4:5] op_sel:[0,0,0] op_sel_hi:[1,0,1]
v_pk_fma_f32 v[12:13], v[244:245], v[42:43], v[12:13] op_sel:[0,1,0] op_sel_hi:[1,1,1]
v_pk_fma_f32 v[14:15], v[246:247], v[42:43], v[14:15] op_sel:[0,1,0] op_sel_hi:[1,1,1]
s_waitcnt lgkmcnt(0)
v_pk_fma_f32 v[2:3], v[248:249], v[44:45], v[2:3] op_sel:[0,0,0] op_sel_hi:[1,0,1]
v_pk_fma_f32 v[4:5], v[250:251], v[44:45], v[4:5] op_sel:[0,0,0] op_sel_hi:[1,0,1]
v_pk_fma_f32 v[12:13], v[248:249], v[44:45], v[12:13] op_sel:[0,1,0] op_sel_hi:[1,1,1]
v_pk_fma_f32 v[14:15], v[250:251], v[44:45], v[14:15] op_sel:[0,1,0] op_sel_hi:[1,1,1]
v_pk_fma_f32 v[2:3], v[252:253], v[46:47], v[2:3] op_sel:[0,0,0] op_sel_hi:[1,0,1]
v_pk_fma_f32 v[4:5], v[254:255], v[46:47], v[4:5] op_sel:[0,0,0] op_sel_hi:[1,0,1]
v_pk_fma_f32 v[12:13], v[252:253], v[46:47], v[12:13] op_sel:[0,1,0] op_sel_hi:[1,1,1]
v_pk_fma_f32 v[14:15], v[254:255], v[46:47], v[14:15] op_sel:[0,1,0] op_sel_hi:[1,1,1]
buffer_store_dwordx4 v[2:5], v103, s[60:63], s96 offen sc1
buffer_store_dwordx4 v[12:15], v109, s[60:63], s97 offen sc1
s_mov_b32 s75, 0

    s_mov_b64 exec, 1
L_pfpre:
    buffer_load_dword v20, v104, s[60:63], s98 offen offset:16 sc1
    s_add_u32 s75, s75, 1
    s_cmp_gt_u32 s75, 20000
    s_cbranch_scc1 L_end
    s_waitcnt vmcnt(0)
    v_cmp_eq_u32 vcc, -1, v20
    s_nop 1
    s_and_b64 exec, exec, vcc
    s_cbranch_execnz L_pfpre
    s_mov_b64 exec, -1

L_pfspin:
    buffer_load_dwordx4 v[20:23], v104, s[60:63], s98 offen sc1
    buffer_load_dwordx4 v[24:27], v104, s[60:63], s98 offen offset:16 sc1
    s_add_u32 s75, s75, 1
    s_cmp_gt_u32 s75, 20000
    s_cbranch_scc1 L_end
    s_waitcnt vmcnt(0)
    v_max3_u32 v28, v20, v21, v22
    v_max3_u32 v29, v23, v24, v25
    v_max3_u32 v28, v28, v26, v27
    v_max_u32 v28, v28, v29
    v_cmp_eq_u32 vcc, -1, v28

    s_nop 1
    s_cmp_eq_u64 vcc, 0
    s_cbranch_scc0 L_pfspin

v_permlane32_swap_b32 v20, v24
v_permlane32_swap_b32 v21, v25
v_permlane32_swap_b32 v22, v26
v_permlane32_swap_b32 v23, v27
v_pk_add_f32 v[20:21], v[20:21], v[24:25]
v_pk_add_f32 v[22:23], v[22:23], v[26:27]
    s_nop 1
v_permlane16_swap_b32 v20, v22
v_permlane16_swap_b32 v21, v23
v_pk_add_f32 v[20:21], v[20:21], v[22:23]
    s_nop 1
v_add_f32_dpp v20, v20, v20 row_ror:1 row_mask:0xf bank_mask:0xf
v_add_f32_dpp v21, v21, v21 row_ror:1 row_mask:0xf bank_mask:0xf
    s_nop 0
v_add_f32_dpp v20, v20, v20 row_ror:2 row_mask:0xf bank_mask:0xf
v_add_f32_dpp v21, v21, v21 row_ror:2 row_mask:0xf bank_mask:0xf
    s_nop 0
v_add_f32_dpp v20, v20, v20 row_ror:4 row_mask:0xf bank_mask:0xf
v_add_f32_dpp v21, v21, v21 row_ror:4 row_mask:0xf bank_mask:0xf
    s_nop 0
v_add_f32_dpp v20, v20, v20 row_ror:8 row_mask:0xf bank_mask:0xf
v_add_f32_dpp v21, v21, v21 row_ror:8 row_mask:0xf bank_mask:0xf
s_mov_b32 exec_lo, 0x00010001
s_mov_b32 exec_hi, 0x00010001
ds_write_b64 v105, v[20:21] offset:2304
s_mov_b64 exec, -1
s_waitcnt lgkmcnt(0)
s_barrier
s_cmp_lg_u32 s3, 0
s_cbranch_scc1 L_end
s_mov_b64 exec, 15
ds_read_b64 v[20:21], v106 offset:2304
ds_read_b64 v[22:23], v106 offset:2336
ds_read_b64 v[24:25], v106 offset:2368
ds_read_b64 v[26:27], v106 offset:2400
s_waitcnt lgkmcnt(0)
v_pk_add_f32 v[20:21], v[20:21], v[22:23]
v_pk_add_f32 v[24:25], v[24:25], v[26:27]
v_pk_add_f32 v[20:21], v[20:21], v[24:25]
v_pk_add_f32 v[20:21], v[20:21], v[110:111]
v_cvt_pk_bf16_f32 v20, v20, v21
buffer_store_dword v20, v107, s[64:67], s9 offen sc1
L_end:
s_endpgm
.section .rodata,"a"
.p2align 6
.amdhsa_kernel parallel_sum__gqa_block_cached__swiglu_ffn__decode_kernel
  .amdhsa_next_free_vgpr 512
  .amdhsa_next_free_sgpr 102
  .amdhsa_accum_offset 256
  .amdhsa_group_segment_fixed_size 0
  .amdhsa_kernarg_size 96
  .amdhsa_user_sgpr_count 2
  .amdhsa_user_sgpr_kernarg_segment_ptr 1
  .amdhsa_system_sgpr_workgroup_id_x 1
  .amdhsa_float_denorm_mode_32 3
.end_amdhsa_kernel
.text
```
